```python
import torch

def _softmax(x, axis=-1):
    return torch.softmax(x, dim=axis)
def _gelu(x):
    return torch.nn.functional.gelu(x, approximate="tanh")
def _silu(x):
    return torch.nn.functional.silu(x)
def _sigmoid(x):
    return torch.sigmoid(x)
def _layernorm(x, axis=-1, eps=1e-5):
    m = x.mean(dim=axis, keepdim=True)
    v = x.var(dim=axis, keepdim=True, unbiased=False)
    return (x - m) / torch.sqrt(v + eps)
def _scatter_add(tgt, idx, src, axis=0):
    return tgt.clone().index_add_(axis, idx, src)
def _segment_sum(src, seg, n):
    out = torch.zeros((n,) + src.shape[1:], dtype=src.dtype)
    return out.index_add_(0, seg, src)
def _pad(x, pw):
    flat = tuple(v for pair in reversed(pw) for v in pair)
    return torch.nn.functional.pad(x, flat)

kernel_name = 'standalone__window_attn_swin__vision'

def setup_inputs():

    _w = (lambda a: (lambda t: t.to(torch.bfloat16) if t.is_floating_point() else t)(torch.as_tensor(a)))
    H = W = 512
    C = 96
    ws = 8
    nh = 4
    shift = ws // 2
    coords = torch.stack(torch.meshgrid(torch.arange(ws), torch.arange(ws), indexing='ij'), 0).reshape(2, -1)
    rel = coords[:, :, None] - coords[:, None, :]
    rel[0] += ws - 1
    rel[1] += ws - 1
    rel[0] *= 2 * ws - 1
    rp_idx = rel.sum(0).to(torch.int64)
    img_mask = torch.zeros((1, H, W, 1), dtype=float)
    cnt = 0
    for hs in (slice(0, H - ws), slice(H - ws, H - shift), slice(H - shift, H)):
        for vs in (slice(0, W - ws), slice(W - ws, W - shift), slice(W - shift, W)):
            img_mask[:, hs, vs, :] = cnt
            cnt += 1
    mw = img_mask.reshape(1, H // ws, ws, W // ws, ws, 1).permute(0, 1, 3, 2, 4, 5).reshape(-1, ws * ws)
    am = mw[:, :, None] - mw[:, None, :]
    attn_mask = torch.where(am != 0, -100.0, 0.0).to(float)
    return {
        "x": _w((lambda *s: torch.randn(*s, dtype=torch.bfloat16) * 1.6)(1, H, W, C)),
        "wqkv": _w((lambda *s: torch.randn(*s, dtype=torch.bfloat16) * 1.6)(C, 3 * C) * 0.02),
        "wo": _w((lambda *s: torch.randn(*s, dtype=torch.bfloat16) * 0.05)(C, C) * 0.02),
        "rpb": _w((lambda *s: torch.randn(*s, dtype=torch.bfloat16) * 0.4)((2 * ws - 1) * (2 * ws - 1), nh)),
        "rp_idx": _w(rp_idx),
        "attn_mask": _w(attn_mask),
    }

def reference(x, wqkv, wo, rpb, rp_idx, attn_mask):
    B, H, W, C = x.shape
    N = rp_idx.shape[0]
    ws = int(round(N ** 0.5))
    nh = rpb.shape[-1]
    hd = C // nh
    shift = ws // 2
    xs = torch.roll(x, (-shift, -shift), (1, 2))
    nWh = H // ws
    nWw = W // ws
    xw = (lambda x, *d: x.permute(*d))(xs.reshape(B, nWh, ws, nWw, ws, C), 0, 1, 3, 2, 4, 5).reshape(B * nWh * nWw, N, C)
    qkv = (lambda x, *d: x.permute(*d))(torch.einsum('wnc,cd->wnd', xw, wqkv).reshape(-1, N, 3, nh, hd), 2, 0, 3, 1, 4)
    q, k, v = qkv[0], qkv[1], qkv[2]
    attn = torch.einsum('whid,whjd->whij', q, k) * (hd ** -0.5)
    bias = (lambda x, *d: x.permute(*d))(rpb[rp_idx.reshape(-1)].reshape(N, N, nh), 2, 0, 1)
    attn = attn + bias[None, :, :, :]
    attn = (attn.reshape(B, nWh * nWw, nh, N, N) + attn_mask[None, :, None, :, :]).reshape(-1, nh, N, N)
    attn = _softmax(attn, axis=-1)
    out = (lambda x, *d: x.permute(*d))(torch.einsum('whij,whjd->whid', attn, v), 0, 2, 1, 3).reshape(-1, N, C)
    out = torch.einsum('wnc,cd->wnd', out, wo)
    out = (lambda x, *d: x.permute(*d))(out.reshape(B, nWh, nWw, ws, ws, C), 0, 1, 3, 2, 4, 5).reshape(B, H, W, C)
    return torch.roll(out, (shift, shift), (1, 2))
```

```asm
; @launch grid=(256,1,1) block=(512,1,1) lds=145984
.amdgcn_target "amdgcn-amd-amdhsa--gfx950"
.text
.globl standalone__window_attn_swin__vision_kernel
.p2align 8
.type standalone__window_attn_swin__vision_kernel,@function
standalone__window_attn_swin__vision_kernel:
    s_cmp_ge_u32 s2, 256
    s_cbranch_scc1 L_end
    s_load_dwordx8 s[4:11], s[0:1], 0
    s_load_dwordx2 s[12:13], s[0:1], 48
    s_getpc_b64 s[40:41]
L_pc:
    v_lshlrev_b32 v1, 7, v0
    v_min_u32 v1, L_end-L_pc, v1
    global_load_dword v239, v1, s[40:41]
    v_lshrrev_b32 v252, 6, v0
    v_and_b32 v253, 63, v0
    v_readfirstlane_b32 s36, v252
    v_lshlrev_b32 v240, 4, v253
    s_lshr_b32 s37, s2, 2
    s_and_b32 s38, s2, 3
    s_lshl_b32 s38, s38, 4
    s_lshl_b32 s72, s37, 3
    s_add_u32 s65, s72, 4
    s_mul_i32 s65, s65, 98304
    s_add_u32 s38, s38, s36
    v_add_u32 v96, 1024, v240
    v_add_u32 v97, 97792, v240
    v_cmp_gt_u32 vcc, 32, v253
    s_mul_i32 s44, s38, 1536
    s_add_u32 s44, s44, s65
    s_add_u32 s44, s44, 768
    v_cndmask_b32 v96, v97, v96, vcc
    s_add_u32 s45, s44, 196608
    s_add_u32 s46, s44, 98816
    s_add_u32 s47, s45, 98816
    v_add_u32 v252, 0, v253
    v_mul_u32_u24 v254, 43691, v252
    v_lshrrev_b32 v250, 19, v254
    v_mul_u32_u24 v250, 384, v250
    v_lshl_add_u32 v92, v252, 4, v250
    v_add_u32 v252, 64, v253
    v_mul_u32_u24 v254, 43691, v252
    v_lshrrev_b32 v250, 19, v254
    v_mul_u32_u24 v250, 384, v250
    v_lshl_add_u32 v93, v252, 4, v250
    v_add_u32 v252, 128, v253
    v_mul_u32_u24 v254, 43691, v252
    v_lshrrev_b32 v250, 19, v254
    v_mul_u32_u24 v250, 384, v250
    v_lshl_add_u32 v94, v252, 4, v250
    v_and_b32 v88, 0xff, v0
    v_mul_u32_u24 v89, 43691, v88
    v_lshrrev_b32 v89, 19, v89
    v_mad_u32_u24 v90, v89, 3, v88
    v_lshlrev_b32 v90, 3, v90
    s_mul_i32 s76, s36, 9216
    s_sub_u32 s73, s36, 6
    s_mul_i32 s73, s73, 27648
    s_add_u32 s77, s76, 6144
    s_add_u32 s76, s76, 384
    s_add_u32 s74, s73, 3072
    s_add_u32 s73, s73, 192
    s_cmp_ge_u32 s36, 6
    s_cselect_b32 s76, s73, s76
    s_cselect_b32 s77, s74, s77
    s_mov_b32 s26, 55296
    s_mov_b32 s27, 0x20000
    s_mov_b32 s34, 1800
    s_mov_b32 s35, 0x20000
    s_mov_b32 s18, 50331648
    s_mov_b32 s19, 0x20000
    s_mov_b32 m0, s77
    s_waitcnt lgkmcnt(0)
    s_mov_b64 s[24:25], s[6:7]
    s_mov_b64 s[16:17], s[4:5]
    s_mov_b64 s[32:33], s[10:11]
    buffer_load_dwordx4 v92, s[24:27], s76 offen lds
    s_add_u32 m0, m0, 1024
    s_nop 0
    buffer_load_dwordx4 v93, s[24:27], s76 offen lds
    s_add_u32 m0, m0, 1024
    s_nop 0
    buffer_load_dwordx4 v94, s[24:27], s76 offen lds
    s_cmp_ge_u32 s36, 4
    s_cbranch_scc1 L_y1
    buffer_load_dwordx4 v[80:83], v90, s[32:35], 0 offen offset:0
    buffer_load_dwordx4 v[84:87], v90, s[32:35], 0 offen offset:16
    buffer_load_dwordx4 v[0:3], v240, s[16:19], s44 offen offset:0 nt
    buffer_load_dwordx4 v[4:7], v96, s[16:19], s44 offen offset:0 nt
    buffer_load_dwordx4 v[8:11], v240, s[16:19], s46 offen offset:0 nt
    buffer_load_dwordx4 v[12:15], v240, s[16:19], s45 offen offset:0 nt
    buffer_load_dwordx4 v[16:19], v96, s[16:19], s45 offen offset:0 nt
    buffer_load_dwordx4 v[20:23], v240, s[16:19], s47 offen offset:0 nt
    s_branch L_iss
L_y1:
    s_cmp_lt_u32 s36, 6
    s_cbranch_scc1 L_iss
    s_add_u32 m0, m0, 7168
    s_add_u32 s76, s76, 9216
    buffer_load_dwordx4 v92, s[24:27], s76 offen lds
    s_add_u32 m0, m0, 1024
    s_nop 0
    buffer_load_dwordx4 v93, s[24:27], s76 offen lds
    s_add_u32 m0, m0, 1024
    s_nop 0
    buffer_load_dwordx4 v94, s[24:27], s76 offen lds
    s_add_u32 m0, m0, 7168
    s_add_u32 s76, s76, 9216
    buffer_load_dwordx4 v92, s[24:27], s76 offen lds
    s_add_u32 m0, m0, 1024
    s_nop 0
    buffer_load_dwordx4 v93, s[24:27], s76 offen lds
    s_add_u32 m0, m0, 1024
    s_nop 0
    buffer_load_dwordx4 v94, s[24:27], s76 offen lds
L_iss:
    s_mov_b64 s[28:29], s[8:9]
    s_mov_b32 s30, 18432
    s_mov_b32 s31, 0x20000
    s_mov_b64 s[20:21], s[12:13]
    s_mov_b32 s22, 50331648
    s_mov_b32 s23, 0x20000
    v_mad_u32_u24 v91, v89, 12, v88
    v_lshlrev_b32 v91, 4, v91
    v_add_u32 v91, 73728, v91
    s_add_u32 s39, s38, 8
    s_lshl_b32 s66, s37, 3
    s_add_u32 s66, s66, 8
    s_and_b32 s66, s66, 511
    s_mul_i32 s66, s66, 98304
    s_mul_i32 s72, s38, 1536
    s_add_u32 s72, s72, 768
    s_cmp_eq_u32 s38, 63
    s_cselect_b32 s72, 0, s72
    s_add_u32 s44, s65, s72
    s_add_u32 s45, s44, 196608
    s_add_u32 s46, s66, s72
    s_add_u32 s47, s46, 196608
    s_mul_i32 s72, s39, 1536
    s_add_u32 s72, s72, 768
    s_cmp_eq_u32 s39, 63
    s_cselect_b32 s72, 0, s72
    s_add_u32 s48, s65, s72
    s_add_u32 s49, s48, 196608
    s_add_u32 s50, s66, s72
    s_add_u32 s51, s50, 196608
    s_mov_b32 s73, 96768
    v_add_u32 v252, 0, v253
    v_mul_u32_u24 v254, 43691, v252
    v_lshrrev_b32 v254, 19, v254
    v_lshrrev_b32 v250, 2, v254
    v_sub_u32 v250, v250, v254
    v_and_b32 v250, 3, v250
    v_sub_u32 v247, v252, v250
    v_mul_u32_u24 v250, 12, v254
    v_cmp_lt_i32 vcc, v247, v250
    v_add_u32 v252, 12, v247
    v_lshrrev_b32 v254, 3, v254
    v_cndmask_b32 v247, v247, v252, vcc
    v_lshlrev_b32 v247, 4, v247
    v_mad_u32_u24 v247, v254, s73, v247
    v_add_u32 v252, 64, v253
    v_mul_u32_u24 v254, 43691, v252
    v_lshrrev_b32 v254, 19, v254
    v_lshrrev_b32 v250, 2, v254
    v_sub_u32 v250, v250, v254
    v_and_b32 v250, 3, v250
    v_sub_u32 v248, v252, v250
    v_mul_u32_u24 v250, 12, v254
    v_cmp_lt_i32 vcc, v248, v250
    v_add_u32 v252, 12, v248
    v_lshrrev_b32 v254, 3, v254
    v_cndmask_b32 v248, v248, v252, vcc
    v_lshlrev_b32 v248, 4, v248
    v_mad_u32_u24 v248, v254, s73, v248
    v_add_u32 v252, 128, v253
    v_mul_u32_u24 v254, 43691, v252
    v_lshrrev_b32 v254, 19, v254
    v_lshrrev_b32 v250, 2, v254
    v_sub_u32 v250, v250, v254
    v_and_b32 v250, 3, v250
    v_sub_u32 v249, v252, v250
    v_mul_u32_u24 v250, 12, v254
    v_cmp_lt_i32 vcc, v249, v250
    v_add_u32 v252, 12, v249
    v_lshrrev_b32 v254, 3, v254
    v_cndmask_b32 v249, v249, v252, vcc
    v_lshlrev_b32 v249, 4, v249
    v_mad_u32_u24 v249, v254, s73, v249
    s_cmp_eq_u32 s37, 63
    s_cselect_b32 s62, 11520, 0
    s_mov_b32 s52, 0xff
    s_mov_b32 s53, 0xff
    s_mov_b32 s54, 0xff00
    s_mov_b32 s55, 0xff00
    s_mov_b32 s56, 0xff0000
    s_mov_b32 s57, 0xff0000
    s_mov_b32 s63, 0
    s_mul_i32 s68, s36, 6144
    s_add_u32 s68, s68, 96768
    v_add_u32 v244, s68, v240
    v_and_b32 v252, 31, v253
    v_lshrrev_b32 v254, 2, v252
    v_sub_u32 v254, v254, v252
    v_and_b32 v254, 3, v254
    v_lshrrev_b32 v250, 5, v253
    v_add_u32 v254, v254, v250
    v_mul_u32_u24 v252, 192, v252
    v_lshl_add_u32 v252, v254, 4, v252
    v_add_u32 v243, s68, v252
    v_cmp_le_u32 vcc, 4, v254
    v_add_u32 v245, 128, v243
    v_subrev_u32 v252, 192, v245
    v_cndmask_b32 v245, v245, v252, vcc
    v_cmp_le_u32 vcc, 2, v254
    v_add_u32 v246, 160, v243
    v_subrev_u32 v252, 192, v246
    v_cndmask_b32 v246, v246, v252, vcc
    v_bfe_u32 v252, v253, 3, 2
    v_mul_u32_u24 v252, 24, v252
    v_and_b32 v250, 7, v253
    v_add_u32 v252, v252, v250
    v_lshrrev_b32 v254, 5, v253
    v_lshlrev_b32 v254, 2, v254
    v_sub_u32 v252, v252, v254
    v_lshlrev_b32 v252, 4, v252
    v_add_u32 v241, 73792, v252
    v_add_u32 v242, s62, v241
    v_and_b32 v252, 3, v253
    v_cmp_eq_u32 vcc, 0, v252
    v_mov_b32 v254, 0x3f803f80
    s_nop 0
    v_cndmask_b32 v176, 0, v254, vcc
    v_mov_b32 v177, v176
    v_mov_b32 v178, v176
    v_mov_b32 v179, v176
    v_mov_b32 v180, v176
    v_mov_b32 v181, v176
    v_mov_b32 v182, v176
    v_mov_b32 v183, v176
    v_mov_b32 v184, v176
    v_mov_b32 v185, v176
    v_mov_b32 v186, v176
    v_mov_b32 v187, v176
    v_mov_b32 v188, v176
    v_mov_b32 v189, v176
    v_mov_b32 v190, v176
    v_mov_b32 v191, v176
    v_mov_b32 v192, v176
    v_mov_b32 v193, v176
    v_mov_b32 v194, v176
    v_mov_b32 v195, v176
    v_mov_b32 v196, v176
    v_mov_b32 v197, v176
    v_mov_b32 v198, v176
    v_mov_b32 v199, v176
    v_mov_b32 v200, v176
    v_mov_b32 v201, v176
    v_mov_b32 v202, v176
    v_mov_b32 v203, v176
    v_mov_b32 v204, v176
    v_mov_b32 v205, v176
    v_mov_b32 v206, v176
    v_mov_b32 v207, v176
    v_mov_b32 v208, v176
    v_mov_b32 v209, v176
    v_mov_b32 v210, v176
    v_mov_b32 v211, v176
    v_mov_b32 v212, v176
    v_mov_b32 v213, v176
    v_mov_b32 v214, v176
    v_mov_b32 v215, v176
    v_mov_b32 v216, v176
    v_mov_b32 v217, v176
    v_mov_b32 v218, v176
    v_mov_b32 v219, v176
    v_mov_b32 v220, v176
    v_mov_b32 v221, v176
    v_mov_b32 v222, v176
    v_mov_b32 v223, v176
    v_mov_b32 v224, v176
    v_mov_b32 v225, v176
    v_mov_b32 v226, v176
    v_mov_b32 v227, v176
    v_mov_b32 v228, v176
    v_mov_b32 v229, v176
    v_mov_b32 v230, v176
    v_mov_b32 v231, v176
    v_mov_b32 v232, v176
    v_mov_b32 v233, v176
    v_mov_b32 v234, v176
    v_mov_b32 v235, v176
    v_mov_b32 v236, v176
    v_mov_b32 v237, v176
    v_mov_b32 v238, v176
    v_bfe_u32 v106, v253, 2, 2
    v_lshrrev_b32 v107, 5, v253
    v_lshl_add_u32 v108, v107, 3, v106
    v_mul_u32_u24 v109, 192, v108
    v_lshl_add_u32 v108, v107, 2, v106
    v_mul_u32_u24 v101, 192, v108
    v_bfe_u32 v106, v253, 4, 1
    v_lshl_add_u32 v101, v106, 5, v101
    v_and_b32 v108, 1, v253
    v_lshl_add_u32 v101, v108, 4, v101
    v_lshl_add_u32 v109, v108, 3, v109
    v_bfe_u32 v108, v253, 1, 1
    v_lshl_add_u32 v101, v108, 3, v101
    v_lshl_add_u32 v106, v106, 1, v108
    v_lshl_add_u32 v100, v106, 4, v109
    v_add_u32 v109, s77, v109
    v_lshlrev_b32 v106, 3, v106
    s_mov_b32 s78, 0x10080048
    v_lshrrev_b32 v107, v106, s78
    v_and_b32 v107, 0xff, v107
    v_lshl_add_u32 v102, v107, 1, v109
    s_mov_b32 s78, 0x28205018
    v_lshrrev_b32 v107, v106, s78
    v_and_b32 v107, 0xff, v107
    v_lshl_add_u32 v103, v107, 1, v109
    s_mov_b32 s78, 0x40583830
    v_lshrrev_b32 v107, v106, s78
    v_and_b32 v107, 0xff, v107
    v_lshl_add_u32 v104, v107, 1, v109
    v_add_u32 v105, s77, v240
    s_cmp_ge_u32 s36, 4
    s_cbranch_scc1 L_ypre
    v_add_u32 v252, 0, v253
    v_mul_u32_u24 v254, 43691, v252
    v_lshrrev_b32 v254, 19, v254
    v_lshrrev_b32 v250, 2, v254
    v_sub_u32 v250, v250, v254
    v_and_b32 v250, 3, v250
    v_add_u32 v112, v252, v250
    v_mad_u32_u24 v250, v254, 12, 12
    v_cmp_ge_u32 vcc, v112, v250
    v_subrev_u32 v252, 12, v112
    s_nop 0
    v_cndmask_b32 v112, v112, v252, vcc
    v_lshl_add_u32 v112, v112, 4, s68
    v_add_u32 v252, 64, v253
    v_mul_u32_u24 v254, 43691, v252
    v_lshrrev_b32 v254, 19, v254
    v_lshrrev_b32 v250, 2, v254
    v_sub_u32 v250, v250, v254
    v_and_b32 v250, 3, v250
    v_add_u32 v113, v252, v250
    v_mad_u32_u24 v250, v254, 12, 12
    v_cmp_ge_u32 vcc, v113, v250
    v_subrev_u32 v252, 12, v113
    s_nop 0
    v_cndmask_b32 v113, v113, v252, vcc
    v_lshl_add_u32 v113, v113, 4, s68
    v_add_u32 v252, 128, v253
    v_mul_u32_u24 v254, 43691, v252
    v_lshrrev_b32 v254, 19, v254
    v_lshrrev_b32 v250, 2, v254
    v_sub_u32 v250, v250, v254
    v_and_b32 v250, 3, v250
    v_add_u32 v114, v252, v250
    v_mad_u32_u24 v250, v254, 12, 12
    v_cmp_ge_u32 vcc, v114, v250
    v_subrev_u32 v252, 12, v114
    s_nop 0
    v_cndmask_b32 v114, v114, v252, vcc
    v_lshl_add_u32 v114, v114, 4, s68
    s_waitcnt vmcnt(6)
    ds_read_b64_tr_b16 v[128:129], v102 offset:0
    ds_read_b64_tr_b16 v[130:131], v102 offset:768
    ds_read_b64_tr_b16 v[132:133], v103 offset:0
    ds_read_b64_tr_b16 v[134:135], v103 offset:768
    ds_read_b64_tr_b16 v[136:137], v104 offset:0
    ds_read_b64_tr_b16 v[138:139], v104 offset:768
    s_waitcnt lgkmcnt(4)
    ds_write_b128 v105, v[128:131] offset:0
    s_waitcnt lgkmcnt(3)
    ds_write_b128 v105, v[132:135] offset:1024
    s_waitcnt lgkmcnt(2)
    ds_write_b128 v105, v[136:139] offset:2048
    s_cmp_eq_u32 s36, 3
    s_cbranch_scc1 L_nobias
    s_mov_b32 s78, 0x3fb8aa3b
    s_mov_b32 s79, 0x431044fe
    v_cmp_gt_u32 vcc, 180, v88
    s_nop 3
    s_mov_b64 exec, vcc
    v_lshlrev_b32 v144, 16, v86
    v_mul_f32 v144, s78, v144
    v_subrev_f32 v148, s79, v144
    v_lshlrev_b32 v145, 16, v84
    v_mul_f32 v145, s78, v145
    v_subrev_f32 v149, s79, v145
    v_lshlrev_b32 v146, 16, v82
    v_mul_f32 v146, s78, v146
    v_subrev_f32 v150, s79, v146
    v_lshlrev_b32 v147, 16, v80
    v_mul_f32 v147, s78, v147
    v_subrev_f32 v151, s79, v147
    ds_write_b128 v91, v[144:147] offset:0
    ds_write_b128 v91, v[148:151] offset:11520
    v_and_b32 v152, 0xffff0000, v86
    v_mul_f32 v152, s78, v152
    v_subrev_f32 v156, s79, v152
    v_and_b32 v153, 0xffff0000, v84
    v_mul_f32 v153, s78, v153
    v_subrev_f32 v157, s79, v153
    v_and_b32 v154, 0xffff0000, v82
    v_mul_f32 v154, s78, v154
    v_subrev_f32 v158, s79, v154
    v_and_b32 v155, 0xffff0000, v80
    v_mul_f32 v155, s78, v155
    v_subrev_f32 v159, s79, v155
    ds_write_b128 v91, v[152:155] offset:192
    ds_write_b128 v91, v[156:159] offset:11712
    v_lshlrev_b32 v160, 16, v87
    v_mul_f32 v160, s78, v160
    v_subrev_f32 v164, s79, v160
    v_lshlrev_b32 v161, 16, v85
    v_mul_f32 v161, s78, v161
    v_subrev_f32 v165, s79, v161
    v_lshlrev_b32 v162, 16, v83
    v_mul_f32 v162, s78, v162
    v_subrev_f32 v166, s79, v162
    v_lshlrev_b32 v163, 16, v81
    v_mul_f32 v163, s78, v163
    v_subrev_f32 v167, s79, v163
    ds_write_b128 v91, v[160:163] offset:5760
    ds_write_b128 v91, v[164:167] offset:17280
    v_and_b32 v168, 0xffff0000, v87
    v_mul_f32 v168, s78, v168
    v_subrev_f32 v172, s79, v168
    v_and_b32 v169, 0xffff0000, v85
    v_mul_f32 v169, s78, v169
    v_subrev_f32 v173, s79, v169
    v_and_b32 v170, 0xffff0000, v83
    v_mul_f32 v170, s78, v170
    v_subrev_f32 v174, s79, v170
    v_and_b32 v171, 0xffff0000, v81
    v_mul_f32 v171, s78, v171
    v_subrev_f32 v175, s79, v171
    ds_write_b128 v91, v[168:171] offset:5952
    ds_write_b128 v91, v[172:175] offset:17472
    s_mov_b64 exec, -1
L_nobias:
    buffer_load_dwordx4 v[24:27], v247, s[16:19], s46 offen offset:0 nt
    buffer_load_dwordx4 v[28:31], v248, s[16:19], s46 offen offset:0 nt
    buffer_load_dwordx4 v[32:35], v249, s[16:19], s46 offen offset:0 nt
    buffer_load_dwordx4 v[36:39], v247, s[16:19], s47 offen offset:0 nt
    buffer_load_dwordx4 v[40:43], v248, s[16:19], s47 offen offset:0 nt
    buffer_load_dwordx4 v[44:47], v249, s[16:19], s47 offen offset:0 nt
    s_waitcnt vmcnt(11)
    ds_write_b128 v112, v[0:3] offset:0
    s_waitcnt vmcnt(10)
    ds_write_b128 v113, v[4:7] offset:0
    s_waitcnt vmcnt(9)
    ds_write_b128 v114, v[8:11] offset:0
    s_waitcnt vmcnt(8)
    ds_write_b128 v112, v[12:15] offset:3072
    s_waitcnt vmcnt(7)
    ds_write_b128 v113, v[16:19] offset:3072
    s_waitcnt vmcnt(6)
    ds_write_b128 v114, v[20:23] offset:3072
    ds_read_b128 v[0:3], v243 offset:0
    ds_read_b128 v[4:7], v243 offset:32
    ds_read_b128 v[8:11], v243 offset:64
    ds_read_b128 v[12:15], v243 offset:96
    ds_read_b128 v[16:19], v245 offset:0
    ds_read_b128 v[20:23], v246 offset:0
    s_waitcnt lgkmcnt(0)
    s_barrier
    s_branch L_go
L_ypre:
    s_waitcnt vmcnt(0)
    s_cmp_ge_u32 s36, 6
    s_cbranch_scc1 L_ykst
    ds_read_b64_tr_b16 v[128:129], v102 offset:0
    ds_read_b64_tr_b16 v[130:131], v102 offset:768
    ds_read_b64_tr_b16 v[132:133], v103 offset:0
    ds_read_b64_tr_b16 v[134:135], v103 offset:768
    ds_read_b64_tr_b16 v[136:137], v104 offset:0
    ds_read_b64_tr_b16 v[138:139], v104 offset:768
    s_waitcnt lgkmcnt(4)
    ds_write_b128 v105, v[128:131] offset:0
    s_waitcnt lgkmcnt(3)
    ds_write_b128 v105, v[132:135] offset:1024
    s_waitcnt lgkmcnt(2)
    ds_write_b128 v105, v[136:139] offset:2048
    s_branch L_ybar
L_ykst:
    v_add_u32 v108, s77, v100
    ds_read_b64_tr_b16 v[128:129], v108 offset:0
    ds_read_b64_tr_b16 v[130:131], v108 offset:768
    ds_read_b64_tr_b16 v[132:133], v108 offset:64
    ds_read_b64_tr_b16 v[134:135], v108 offset:832
    ds_read_b64_tr_b16 v[136:137], v108 offset:128
    ds_read_b64_tr_b16 v[138:139], v108 offset:896
    ds_read_b64_tr_b16 v[140:141], v108 offset:9216
    ds_read_b64_tr_b16 v[142:143], v108 offset:9984
    ds_read_b64_tr_b16 v[144:145], v108 offset:9280
    ds_read_b64_tr_b16 v[146:147], v108 offset:10048
    ds_read_b64_tr_b16 v[148:149], v108 offset:9344
    ds_read_b64_tr_b16 v[150:151], v108 offset:10112
    ds_read_b64_tr_b16 v[152:153], v108 offset:18432
    ds_read_b64_tr_b16 v[154:155], v108 offset:19200
    ds_read_b64_tr_b16 v[156:157], v108 offset:18496
    s_waitcnt lgkmcnt(13)
    ds_read_b64_tr_b16 v[158:159], v108 offset:19264
    ds_read_b64_tr_b16 v[160:161], v108 offset:18560
    s_waitcnt lgkmcnt(13)
    ds_read_b64_tr_b16 v[162:163], v108 offset:19328
    ds_write_b128 v105, v[128:131] offset:0
    s_waitcnt lgkmcnt(13)
    ds_write_b128 v105, v[132:135] offset:1024
    ds_write_b128 v105, v[136:139] offset:2048
    s_waitcnt lgkmcnt(13)
    ds_write_b128 v105, v[140:143] offset:9216
    s_waitcnt lgkmcnt(12)
    ds_write_b128 v105, v[144:147] offset:10240
    s_waitcnt lgkmcnt(11)
    ds_write_b128 v105, v[148:151] offset:11264
    s_waitcnt lgkmcnt(10)
    ds_write_b128 v105, v[152:155] offset:18432
    s_waitcnt lgkmcnt(9)
    ds_write_b128 v105, v[156:159] offset:19456
    s_waitcnt lgkmcnt(8)
    ds_write_b128 v105, v[160:163] offset:20480
L_ybar:
    s_waitcnt lgkmcnt(0)
    s_barrier
    s_sub_u32 s72, s36, 4
    s_lshl_b32 s72, s72, 1
    s_min_u32 s72, s72, 5
    s_mul_i32 s81, s72, 9216
    s_mov_b32 m0, s81
    s_mov_b32 s78, 0x3e96c740
    buffer_load_dwordx4 v92, s[24:27], s81 offen lds
    s_add_u32 m0, m0, 1024
    s_nop 0
    buffer_load_dwordx4 v93, s[24:27], s81 offen lds
    s_add_u32 m0, m0, 1024
    s_nop 0
    buffer_load_dwordx4 v94, s[24:27], s81 offen lds
    s_cmp_ge_u32 s36, 6
    s_cbranch_scc1 L_ywo
    s_add_u32 s82, s81, 9216
    s_mov_b32 m0, s82
    s_nop 0
    buffer_load_dwordx4 v92, s[24:27], s82 offen lds
    s_add_u32 m0, m0, 1024
    s_nop 0
    buffer_load_dwordx4 v93, s[24:27], s82 offen lds
    s_add_u32 m0, m0, 1024
    s_nop 0
    buffer_load_dwordx4 v94, s[24:27], s82 offen lds
    s_waitcnt vmcnt(3)
    v_add_u32 v108, s81, v100
    v_add_u32 v105, s81, v240
    ds_read_b64_tr_b16 v[128:129], v108 offset:0
    ds_read_b64_tr_b16 v[130:131], v108 offset:768
    ds_read_b64_tr_b16 v[132:133], v108 offset:64
    ds_read_b64_tr_b16 v[134:135], v108 offset:832
    ds_read_b64_tr_b16 v[136:137], v108 offset:128
    ds_read_b64_tr_b16 v[138:139], v108 offset:896
    s_waitcnt lgkmcnt(5)
    v_lshlrev_b32 v106, 16, v128
    v_and_b32 v107, 0xffff0000, v128
    v_mul_f32 v106, s78, v106
    v_mul_f32 v107, s78, v107
    v_cvt_pk_bf16_f32 v128, v106, v107
    v_lshlrev_b32 v106, 16, v129
    v_and_b32 v107, 0xffff0000, v129
    v_mul_f32 v106, s78, v106
    v_mul_f32 v107, s78, v107
    v_cvt_pk_bf16_f32 v129, v106, v107
    s_waitcnt lgkmcnt(4)
    v_lshlrev_b32 v106, 16, v130
    v_and_b32 v107, 0xffff0000, v130
    v_mul_f32 v106, s78, v106
    v_mul_f32 v107, s78, v107
    v_cvt_pk_bf16_f32 v130, v106, v107
    v_lshlrev_b32 v106, 16, v131
    v_and_b32 v107, 0xffff0000, v131
    v_mul_f32 v106, s78, v106
    v_mul_f32 v107, s78, v107
    v_cvt_pk_bf16_f32 v131, v106, v107
    ds_write_b128 v105, v[128:131] offset:0
    s_waitcnt lgkmcnt(4)
    v_lshlrev_b32 v106, 16, v132
    v_and_b32 v107, 0xffff0000, v132
    v_mul_f32 v106, s78, v106
    v_mul_f32 v107, s78, v107
    v_cvt_pk_bf16_f32 v132, v106, v107
    v_lshlrev_b32 v106, 16, v133
    v_and_b32 v107, 0xffff0000, v133
    v_mul_f32 v106, s78, v106
    v_mul_f32 v107, s78, v107
    v_cvt_pk_bf16_f32 v133, v106, v107
    s_waitcnt lgkmcnt(3)
    v_lshlrev_b32 v106, 16, v134
    v_and_b32 v107, 0xffff0000, v134
    v_mul_f32 v106, s78, v106
    v_mul_f32 v107, s78, v107
    v_cvt_pk_bf16_f32 v134, v106, v107
    v_lshlrev_b32 v106, 16, v135
    v_and_b32 v107, 0xffff0000, v135
    v_mul_f32 v106, s78, v106
    v_mul_f32 v107, s78, v107
    v_cvt_pk_bf16_f32 v135, v106, v107
    ds_write_b128 v105, v[132:135] offset:1024
    s_waitcnt lgkmcnt(3)
    v_lshlrev_b32 v106, 16, v136
    v_and_b32 v107, 0xffff0000, v136
    v_mul_f32 v106, s78, v106
    v_mul_f32 v107, s78, v107
    v_cvt_pk_bf16_f32 v136, v106, v107
    v_lshlrev_b32 v106, 16, v137
    v_and_b32 v107, 0xffff0000, v137
    v_mul_f32 v106, s78, v106
    v_mul_f32 v107, s78, v107
    v_cvt_pk_bf16_f32 v137, v106, v107
    s_waitcnt lgkmcnt(2)
    v_lshlrev_b32 v106, 16, v138
    v_and_b32 v107, 0xffff0000, v138
    v_mul_f32 v106, s78, v106
    v_mul_f32 v107, s78, v107
    v_cvt_pk_bf16_f32 v138, v106, v107
    v_lshlrev_b32 v106, 16, v139
    v_and_b32 v107, 0xffff0000, v139
    v_mul_f32 v106, s78, v106
    v_mul_f32 v107, s78, v107
    v_cvt_pk_bf16_f32 v139, v106, v107
    ds_write_b128 v105, v[136:139] offset:2048
    s_waitcnt vmcnt(0)
    v_add_u32 v108, s82, v100
    v_add_u32 v105, s82, v240
    ds_read_b64_tr_b16 v[128:129], v108 offset:0
    ds_read_b64_tr_b16 v[130:131], v108 offset:768
    ds_read_b64_tr_b16 v[132:133], v108 offset:64
    ds_read_b64_tr_b16 v[134:135], v108 offset:832
    ds_read_b64_tr_b16 v[136:137], v108 offset:128
    ds_read_b64_tr_b16 v[138:139], v108 offset:896
    s_waitcnt lgkmcnt(5)
    v_lshlrev_b32 v106, 16, v128
    v_and_b32 v107, 0xffff0000, v128
    v_mul_f32 v106, s78, v106
    v_mul_f32 v107, s78, v107
    v_cvt_pk_bf16_f32 v128, v106, v107
    v_lshlrev_b32 v106, 16, v129
    v_and_b32 v107, 0xffff0000, v129
    v_mul_f32 v106, s78, v106
    v_mul_f32 v107, s78, v107
    v_cvt_pk_bf16_f32 v129, v106, v107
    s_waitcnt lgkmcnt(4)
    v_lshlrev_b32 v106, 16, v130
    v_and_b32 v107, 0xffff0000, v130
    v_mul_f32 v106, s78, v106
    v_mul_f32 v107, s78, v107
    v_cvt_pk_bf16_f32 v130, v106, v107
    v_lshlrev_b32 v106, 16, v131
    v_and_b32 v107, 0xffff0000, v131
    v_mul_f32 v106, s78, v106
    v_mul_f32 v107, s78, v107
    v_cvt_pk_bf16_f32 v131, v106, v107
    ds_write_b128 v105, v[128:131] offset:0
    s_waitcnt lgkmcnt(4)
    v_lshlrev_b32 v106, 16, v132
    v_and_b32 v107, 0xffff0000, v132
    v_mul_f32 v106, s78, v106
    v_mul_f32 v107, s78, v107
    v_cvt_pk_bf16_f32 v132, v106, v107
    v_lshlrev_b32 v106, 16, v133
    v_and_b32 v107, 0xffff0000, v133
    v_mul_f32 v106, s78, v106
    v_mul_f32 v107, s78, v107
    v_cvt_pk_bf16_f32 v133, v106, v107
    s_waitcnt lgkmcnt(3)
    v_lshlrev_b32 v106, 16, v134
    v_and_b32 v107, 0xffff0000, v134
    v_mul_f32 v106, s78, v106
    v_mul_f32 v107, s78, v107
    v_cvt_pk_bf16_f32 v134, v106, v107
    v_lshlrev_b32 v106, 16, v135
    v_and_b32 v107, 0xffff0000, v135
    v_mul_f32 v106, s78, v106
    v_mul_f32 v107, s78, v107
    v_cvt_pk_bf16_f32 v135, v106, v107
    ds_write_b128 v105, v[132:135] offset:1024
    s_waitcnt lgkmcnt(3)
    v_lshlrev_b32 v106, 16, v136
    v_and_b32 v107, 0xffff0000, v136
    v_mul_f32 v106, s78, v106
    v_mul_f32 v107, s78, v107
    v_cvt_pk_bf16_f32 v136, v106, v107
    v_lshlrev_b32 v106, 16, v137
    v_and_b32 v107, 0xffff0000, v137
    v_mul_f32 v106, s78, v106
    v_mul_f32 v107, s78, v107
    v_cvt_pk_bf16_f32 v137, v106, v107
    s_waitcnt lgkmcnt(2)
    v_lshlrev_b32 v106, 16, v138
    v_and_b32 v107, 0xffff0000, v138
    v_mul_f32 v106, s78, v106
    v_mul_f32 v107, s78, v107
    v_cvt_pk_bf16_f32 v138, v106, v107
    v_lshlrev_b32 v106, 16, v139
    v_and_b32 v107, 0xffff0000, v139
    v_mul_f32 v106, s78, v106
    v_mul_f32 v107, s78, v107
    v_cvt_pk_bf16_f32 v139, v106, v107
    ds_write_b128 v105, v[136:139] offset:2048
    s_branch L_ydone
L_ywo:
    s_sub_u32 s72, s36, 6
    s_mul_i32 s82, s72, 9216
    s_add_u32 m0, s82, 55296
    s_mov_b32 s73, s82
    buffer_load_dwordx4 v240, s[28:31], s73 offen lds
    s_add_u32 m0, m0, 1024
    s_add_u32 s73, s73, 1024
    buffer_load_dwordx4 v240, s[28:31], s73 offen lds
    s_add_u32 m0, m0, 1024
    s_add_u32 s73, s73, 1024
    buffer_load_dwordx4 v240, s[28:31], s73 offen lds
    s_add_u32 m0, m0, 1024
    s_add_u32 s73, s73, 1024
    buffer_load_dwordx4 v240, s[28:31], s73 offen lds
    s_add_u32 m0, m0, 1024
    s_add_u32 s73, s73, 1024
    buffer_load_dwordx4 v240, s[28:31], s73 offen lds
    s_add_u32 m0, m0, 1024
    s_add_u32 s73, s73, 1024
    buffer_load_dwordx4 v240, s[28:31], s73 offen lds
    s_add_u32 m0, m0, 1024
    s_add_u32 s73, s73, 1024
    buffer_load_dwordx4 v240, s[28:31], s73 offen lds
    s_add_u32 m0, m0, 1024
    s_add_u32 s73, s73, 1024
    buffer_load_dwordx4 v240, s[28:31], s73 offen lds
    s_add_u32 m0, m0, 1024
    s_add_u32 s73, s73, 1024
    buffer_load_dwordx4 v240, s[28:31], s73 offen lds
    s_waitcnt vmcnt(9)
    v_add_u32 v108, s81, v100
    v_add_u32 v105, s81, v240
    ds_read_b64_tr_b16 v[128:129], v108 offset:0
    ds_read_b64_tr_b16 v[130:131], v108 offset:768
    ds_read_b64_tr_b16 v[132:133], v108 offset:64
    ds_read_b64_tr_b16 v[134:135], v108 offset:832
    ds_read_b64_tr_b16 v[136:137], v108 offset:128
    ds_read_b64_tr_b16 v[138:139], v108 offset:896
    s_waitcnt lgkmcnt(5)
    v_lshlrev_b32 v106, 16, v128
    v_and_b32 v107, 0xffff0000, v128
    v_mul_f32 v106, s78, v106
    v_mul_f32 v107, s78, v107
    v_cvt_pk_bf16_f32 v128, v106, v107
    v_lshlrev_b32 v106, 16, v129
    v_and_b32 v107, 0xffff0000, v129
    v_mul_f32 v106, s78, v106
    v_mul_f32 v107, s78, v107
    v_cvt_pk_bf16_f32 v129, v106, v107
    s_waitcnt lgkmcnt(4)
    v_lshlrev_b32 v106, 16, v130
    v_and_b32 v107, 0xffff0000, v130
    v_mul_f32 v106, s78, v106
    v_mul_f32 v107, s78, v107
    v_cvt_pk_bf16_f32 v130, v106, v107
    v_lshlrev_b32 v106, 16, v131
    v_and_b32 v107, 0xffff0000, v131
    v_mul_f32 v106, s78, v106
    v_mul_f32 v107, s78, v107
    v_cvt_pk_bf16_f32 v131, v106, v107
    ds_write_b128 v105, v[128:131] offset:0
    s_waitcnt lgkmcnt(4)
    v_lshlrev_b32 v106, 16, v132
    v_and_b32 v107, 0xffff0000, v132
    v_mul_f32 v106, s78, v106
    v_mul_f32 v107, s78, v107
    v_cvt_pk_bf16_f32 v132, v106, v107
    v_lshlrev_b32 v106, 16, v133
    v_and_b32 v107, 0xffff0000, v133
    v_mul_f32 v106, s78, v106
    v_mul_f32 v107, s78, v107
    v_cvt_pk_bf16_f32 v133, v106, v107
    s_waitcnt lgkmcnt(3)
    v_lshlrev_b32 v106, 16, v134
    v_and_b32 v107, 0xffff0000, v134
    v_mul_f32 v106, s78, v106
    v_mul_f32 v107, s78, v107
    v_cvt_pk_bf16_f32 v134, v106, v107
    v_lshlrev_b32 v106, 16, v135
    v_and_b32 v107, 0xffff0000, v135
    v_mul_f32 v106, s78, v106
    v_mul_f32 v107, s78, v107
    v_cvt_pk_bf16_f32 v135, v106, v107
    ds_write_b128 v105, v[132:135] offset:1024
    s_waitcnt lgkmcnt(3)
    v_lshlrev_b32 v106, 16, v136
    v_and_b32 v107, 0xffff0000, v136
    v_mul_f32 v106, s78, v106
    v_mul_f32 v107, s78, v107
    v_cvt_pk_bf16_f32 v136, v106, v107
    v_lshlrev_b32 v106, 16, v137
    v_and_b32 v107, 0xffff0000, v137
    v_mul_f32 v106, s78, v106
    v_mul_f32 v107, s78, v107
    v_cvt_pk_bf16_f32 v137, v106, v107
    s_waitcnt lgkmcnt(2)
    v_lshlrev_b32 v106, 16, v138
    v_and_b32 v107, 0xffff0000, v138
    v_mul_f32 v106, s78, v106
    v_mul_f32 v107, s78, v107
    v_cvt_pk_bf16_f32 v138, v106, v107
    v_lshlrev_b32 v106, 16, v139
    v_and_b32 v107, 0xffff0000, v139
    v_mul_f32 v106, s78, v106
    v_mul_f32 v107, s78, v107
    v_cvt_pk_bf16_f32 v139, v106, v107
    ds_write_b128 v105, v[136:139] offset:2048
    s_add_u32 s72, s82, 55296
    v_add_u32 v108, s72, v101
    v_add_u32 v109, s72, v240
    s_waitcnt vmcnt(0)
    ds_read_b64_tr_b16 v[48:49], v108 offset:0
    ds_read_b64_tr_b16 v[50:51], v108 offset:1536
    ds_read_b64_tr_b16 v[52:53], v108 offset:64
    ds_read_b64_tr_b16 v[54:55], v108 offset:1600
    ds_read_b64_tr_b16 v[56:57], v108 offset:128
    ds_read_b64_tr_b16 v[58:59], v108 offset:1664
    ds_read_b64_tr_b16 v[60:61], v108 offset:3072
    ds_read_b64_tr_b16 v[62:63], v108 offset:4608
    ds_read_b64_tr_b16 v[64:65], v108 offset:3136
    ds_read_b64_tr_b16 v[66:67], v108 offset:4672
    ds_read_b64_tr_b16 v[68:69], v108 offset:3200
    ds_read_b64_tr_b16 v[70:71], v108 offset:4736
    s_waitcnt lgkmcnt(13)
    ds_read_b64_tr_b16 v[72:73], v108 offset:6144
    ds_read_b64_tr_b16 v[74:75], v108 offset:7680
    s_waitcnt lgkmcnt(13)
    ds_read_b64_tr_b16 v[76:77], v108 offset:6208
    ds_read_b64_tr_b16 v[78:79], v108 offset:7744
    s_waitcnt lgkmcnt(13)
    ds_read_b64_tr_b16 v[80:81], v108 offset:6272
    ds_read_b64_tr_b16 v[82:83], v108 offset:7808
    s_waitcnt lgkmcnt(13)
    ds_write_b128 v109, v[48:51] offset:0
    ds_write_b128 v109, v[52:55] offset:1024
    s_waitcnt lgkmcnt(14)
    ds_write_b128 v109, v[56:59] offset:2048
    s_waitcnt lgkmcnt(13)
    ds_write_b128 v109, v[60:63] offset:3072
    s_waitcnt lgkmcnt(12)
    ds_write_b128 v109, v[64:67] offset:4096
    s_waitcnt lgkmcnt(11)
    ds_write_b128 v109, v[68:71] offset:5120
    s_waitcnt lgkmcnt(10)
    ds_write_b128 v109, v[72:75] offset:6144
    s_waitcnt lgkmcnt(9)
    ds_write_b128 v109, v[76:79] offset:7168
    s_waitcnt lgkmcnt(8)
    ds_write_b128 v109, v[80:83] offset:8192
L_ydone:
    s_waitcnt lgkmcnt(0)
    s_barrier
    buffer_load_dwordx4 v[0:3], v247, s[16:19], s44 offen offset:0 nt
    buffer_load_dwordx4 v[4:7], v248, s[16:19], s44 offen offset:0 nt
    buffer_load_dwordx4 v[8:11], v249, s[16:19], s44 offen offset:0 nt
    buffer_load_dwordx4 v[12:15], v247, s[16:19], s45 offen offset:0 nt
    buffer_load_dwordx4 v[16:19], v248, s[16:19], s45 offen offset:0 nt
    buffer_load_dwordx4 v[20:23], v249, s[16:19], s45 offen offset:0 nt
    buffer_load_dwordx4 v[24:27], v247, s[16:19], s46 offen offset:0 nt
    buffer_load_dwordx4 v[28:31], v248, s[16:19], s46 offen offset:0 nt
    buffer_load_dwordx4 v[32:35], v249, s[16:19], s46 offen offset:0 nt
    buffer_load_dwordx4 v[36:39], v247, s[16:19], s47 offen offset:0 nt
    buffer_load_dwordx4 v[40:43], v248, s[16:19], s47 offen offset:0 nt
    buffer_load_dwordx4 v[44:47], v249, s[16:19], s47 offen offset:0 nt
    s_waitcnt vmcnt(11)
    ds_write_b128 v244, v[0:3] offset:0
    s_waitcnt vmcnt(10)
    ds_write_b128 v244, v[4:7] offset:1024
    s_waitcnt vmcnt(9)
    ds_write_b128 v244, v[8:11] offset:2048
    s_waitcnt vmcnt(8)
    ds_write_b128 v244, v[12:15] offset:3072
    s_waitcnt vmcnt(7)
    ds_write_b128 v244, v[16:19] offset:4096
    s_waitcnt vmcnt(6)
    ds_write_b128 v244, v[20:23] offset:5120
    ds_read_b128 v[0:3], v243 offset:0
    ds_read_b128 v[4:7], v243 offset:32
    ds_read_b128 v[8:11], v243 offset:64
    ds_read_b128 v[12:15], v243 offset:96
    ds_read_b128 v[16:19], v245 offset:0
    ds_read_b128 v[20:23], v246 offset:0
    s_waitcnt lgkmcnt(0)
L_go:
    v_mov_b32 v239, v176
    s_setprio 0
    ds_read_b128 v[104:107], v240 offset:6144
    ds_read_b128 v[108:111], v240 offset:15360
    ds_read_b128 v[112:115], v240 offset:24576
    s_waitcnt lgkmcnt(2)
    v_mfma_f32_32x32x16_bf16 v[64:79], v[0:3], v[104:107], 0
    ds_read_b128 v[116:119], v240 offset:33792
    s_waitcnt lgkmcnt(2)
    v_mfma_f32_32x32x16_bf16 v[64:79], v[4:7], v[108:111], v[64:79]
    ds_read_b128 v[80:83], v240 offset:43008
    s_waitcnt lgkmcnt(2)
    v_mfma_f32_32x32x16_bf16 v[64:79], v[8:11], v[112:115], v[64:79]
    ds_read_b128 v[84:87], v240 offset:52224
    s_waitcnt lgkmcnt(2)
    v_mfma_f32_32x32x16_bf16 v[64:79], v[12:15], v[116:119], v[64:79]
    ds_read_b128 v[88:91], v240 offset:7168
    s_waitcnt lgkmcnt(2)
    v_mfma_f32_32x32x16_bf16 v[64:79], v[16:19], v[80:83], v[64:79]
    ds_read_b128 v[92:95], v240 offset:16384
    s_waitcnt lgkmcnt(2)
    v_mfma_f32_32x32x16_bf16 v[64:79], v[20:23], v[84:87], v[64:79]
    ds_read_b128 v[104:107], v240 offset:25600
    s_waitcnt lgkmcnt(2)
    v_mfma_f32_32x32x16_bf16 v[48:63], v[0:3], v[88:91], 0
    ds_read_b128 v[108:111], v240 offset:34816
    s_waitcnt lgkmcnt(2)
    v_mfma_f32_32x32x16_bf16 v[48:63], v[4:7], v[92:95], v[48:63]
    ds_read_b128 v[112:115], v240 offset:44032
    s_waitcnt lgkmcnt(2)
    v_mfma_f32_32x32x16_bf16 v[48:63], v[8:11], v[104:107], v[48:63]
    ds_read_b128 v[116:119], v240 offset:53248
    s_setprio 3
    s_mov_b64 exec, s[52:53]
    v_cvt_pk_bf16_f32 v224, v64, v65
    v_cvt_pk_bf16_f32 v225, v66, v67
    s_not_b64 exec, exec
    v_cvt_pk_bf16_f32 v176, v64, v65
    v_cvt_pk_bf16_f32 v177, v66, v67
    s_mov_b64 exec, -1
    s_setprio 0
    s_waitcnt lgkmcnt(2)
    v_mfma_f32_32x32x16_bf16 v[48:63], v[12:15], v[108:111], v[48:63]
    ds_read_b128 v[80:83], v240 offset:8192
    s_setprio 3
    s_mov_b64 exec, s[52:53]
    v_cvt_pk_bf16_f32 v226, v68, v69
    v_cvt_pk_bf16_f32 v227, v70, v71
    s_not_b64 exec, exec
    v_cvt_pk_bf16_f32 v178, v68, v69
    v_cvt_pk_bf16_f32 v179, v70, v71
    s_mov_b64 exec, -1
    s_setprio 0
    s_waitcnt lgkmcnt(2)
    v_mfma_f32_32x32x16_bf16 v[48:63], v[16:19], v[112:115], v[48:63]
    ds_read_b128 v[84:87], v240 offset:17408
    s_setprio 3
    s_mov_b64 exec, s[52:53]
    v_cvt_pk_bf16_f32 v228, v72, v73
    v_cvt_pk_bf16_f32 v229, v74, v75
    s_not_b64 exec, exec
    v_cvt_pk_bf16_f32 v180, v72, v73
    v_cvt_pk_bf16_f32 v181, v74, v75
    s_mov_b64 exec, -1
    s_setprio 0
    s_waitcnt lgkmcnt(2)
    v_mfma_f32_32x32x16_bf16 v[48:63], v[20:23], v[116:119], v[48:63]
    ds_read_b128 v[88:91], v240 offset:26624
    s_setprio 3
    s_mov_b64 exec, s[52:53]
    v_cvt_pk_bf16_f32 v230, v76, v77
    v_cvt_pk_bf16_f32 v231, v78, v79
    s_not_b64 exec, exec
    v_cvt_pk_bf16_f32 v182, v76, v77
    v_cvt_pk_bf16_f32 v183, v78, v79
    s_mov_b64 exec, -1
    s_setprio 0
    s_waitcnt lgkmcnt(2)
    v_mfma_f32_32x32x16_bf16 v[64:79], v[0:3], v[80:83], 0
    ds_read_b128 v[92:95], v240 offset:35840
    s_waitcnt lgkmcnt(2)
    v_mfma_f32_32x32x16_bf16 v[64:79], v[4:7], v[84:87], v[64:79]
    ds_read_b128 v[104:107], v240 offset:45056
    s_waitcnt lgkmcnt(2)
    v_mfma_f32_32x32x16_bf16 v[64:79], v[8:11], v[88:91], v[64:79]
    ds_read_b128 v[108:111], v240 offset:54272
    s_setprio 3
    s_mov_b64 exec, s[54:55]
    v_cvt_pk_bf16_f32 v224, v48, v49
    v_cvt_pk_bf16_f32 v225, v50, v51
    s_not_b64 exec, exec
    v_cvt_pk_bf16_f32 v192, v48, v49
    v_cvt_pk_bf16_f32 v193, v50, v51
    s_mov_b64 exec, -1
    s_setprio 0
    s_waitcnt lgkmcnt(2)
    v_mfma_f32_32x32x16_bf16 v[64:79], v[12:15], v[92:95], v[64:79]
    ds_read_b128 v[112:115], v240 offset:3072
    s_setprio 3
    s_mov_b64 exec, s[54:55]
    v_cvt_pk_bf16_f32 v226, v52, v53
    v_cvt_pk_bf16_f32 v227, v54, v55
    s_not_b64 exec, exec
    v_cvt_pk_bf16_f32 v194, v52, v53
    v_cvt_pk_bf16_f32 v195, v54, v55
    s_mov_b64 exec, -1
    s_setprio 0
    s_waitcnt lgkmcnt(2)
    v_mfma_f32_32x32x16_bf16 v[64:79], v[16:19], v[104:107], v[64:79]
    ds_read_b128 v[116:119], v240 offset:12288
    s_setprio 3
    s_mov_b64 exec, s[54:55]
    v_cvt_pk_bf16_f32 v228, v56, v57
    v_cvt_pk_bf16_f32 v229, v58, v59
    s_not_b64 exec, exec
    v_cvt_pk_bf16_f32 v196, v56, v57
    v_cvt_pk_bf16_f32 v197, v58, v59
    s_mov_b64 exec, -1
    s_setprio 0
    s_waitcnt lgkmcnt(2)
    v_mfma_f32_32x32x16_bf16 v[64:79], v[20:23], v[108:111], v[64:79]
    ds_read_b128 v[80:83], v240 offset:21504
    s_setprio 3
    s_mov_b64 exec, s[54:55]
    v_cvt_pk_bf16_f32 v230, v60, v61
    v_cvt_pk_bf16_f32 v231, v62, v63
    s_not_b64 exec, exec
    v_cvt_pk_bf16_f32 v198, v60, v61
    v_cvt_pk_bf16_f32 v199, v62, v63
    s_mov_b64 exec, -1
    s_setprio 0
    s_waitcnt lgkmcnt(2)
    v_mfma_f32_32x32x16_bf16 v[48:63], v[112:115], v[0:3], 0
    ds_read_b128 v[84:87], v240 offset:30720
    s_waitcnt lgkmcnt(2)
    v_mfma_f32_32x32x16_bf16 v[48:63], v[116:119], v[4:7], v[48:63]
    ds_read_b128 v[88:91], v240 offset:39936
    s_waitcnt lgkmcnt(2)
    v_mfma_f32_32x32x16_bf16 v[48:63], v[80:83], v[8:11], v[48:63]
    ds_read_b128 v[92:95], v240 offset:49152
    s_setprio 3
    s_mov_b64 exec, s[56:57]
    v_cvt_pk_bf16_f32 v224, v64, v65
    v_cvt_pk_bf16_f32 v225, v66, v67
    s_not_b64 exec, exec
    v_cvt_pk_bf16_f32 v208, v64, v65
    v_cvt_pk_bf16_f32 v209, v66, v67
    s_mov_b64 exec, -1
    s_setprio 0
    s_waitcnt lgkmcnt(2)
    v_mfma_f32_32x32x16_bf16 v[48:63], v[84:87], v[12:15], v[48:63]
    ds_read_b128 v[104:107], v240 offset:4096
    s_setprio 3
    s_mov_b64 exec, s[56:57]
    v_cvt_pk_bf16_f32 v226, v68, v69
    v_cvt_pk_bf16_f32 v227, v70, v71
    s_not_b64 exec, exec
    v_cvt_pk_bf16_f32 v210, v68, v69
    v_cvt_pk_bf16_f32 v211, v70, v71
    s_mov_b64 exec, -1
    s_setprio 0
    s_waitcnt lgkmcnt(2)
    v_mfma_f32_32x32x16_bf16 v[48:63], v[88:91], v[16:19], v[48:63]
    ds_read_b128 v[108:111], v240 offset:13312
    s_setprio 3
    s_mov_b64 exec, s[56:57]
    v_cvt_pk_bf16_f32 v228, v72, v73
    v_cvt_pk_bf16_f32 v229, v74, v75
    s_not_b64 exec, exec
    v_cvt_pk_bf16_f32 v212, v72, v73
    v_cvt_pk_bf16_f32 v213, v74, v75
    s_mov_b64 exec, -1
    s_setprio 0
    s_waitcnt lgkmcnt(2)
    v_mfma_f32_32x32x16_bf16 v[48:63], v[92:95], v[20:23], v[48:63]
    ds_read_b128 v[112:115], v240 offset:22528
    s_setprio 3
    s_mov_b64 exec, s[56:57]
    v_cvt_pk_bf16_f32 v230, v76, v77
    v_cvt_pk_bf16_f32 v231, v78, v79
    s_not_b64 exec, exec
    v_cvt_pk_bf16_f32 v214, v76, v77
    v_cvt_pk_bf16_f32 v215, v78, v79
    s_mov_b64 exec, -1
    s_setprio 0
    s_waitcnt lgkmcnt(2)
    v_mfma_f32_32x32x16_bf16 v[64:79], v[104:107], v[0:3], 0
    ds_read_b128 v[116:119], v240 offset:31744
    s_waitcnt lgkmcnt(2)
    v_mfma_f32_32x32x16_bf16 v[64:79], v[108:111], v[4:7], v[64:79]
    ds_read_b128 v[80:83], v240 offset:40960
    s_waitcnt lgkmcnt(2)
    v_mfma_f32_32x32x16_bf16 v[64:79], v[112:115], v[8:11], v[64:79]
    ds_read_b128 v[84:87], v240 offset:50176
    s_setprio 3
    v_cvt_pk_bf16_f32 v134, v48, v49
    v_cvt_pk_bf16_f32 v135, v50, v51
    v_cvt_pk_bf16_f32 v136, v52, v53
    v_cvt_pk_bf16_f32 v137, v54, v55
    s_setprio 0
    s_waitcnt lgkmcnt(2)
    v_mfma_f32_32x32x16_bf16 v[64:79], v[116:119], v[12:15], v[64:79]
    ds_read_b128 v[88:91], v240 offset:5120
    s_setprio 3
    v_cvt_pk_bf16_f32 v138, v56, v57
    v_cvt_pk_bf16_f32 v139, v58, v59
    v_cvt_pk_bf16_f32 v146, v60, v61
    v_cvt_pk_bf16_f32 v147, v62, v63
    s_setprio 0
    s_waitcnt lgkmcnt(2)
    v_mfma_f32_32x32x16_bf16 v[64:79], v[80:83], v[16:19], v[64:79]
    ds_read_b128 v[92:95], v240 offset:14336
    s_waitcnt lgkmcnt(2)
    v_mfma_f32_32x32x16_bf16 v[64:79], v[84:87], v[20:23], v[64:79]
    ds_read_b128 v[104:107], v240 offset:23552
    s_waitcnt lgkmcnt(2)
    v_mfma_f32_32x32x16_bf16 v[48:63], v[88:91], v[0:3], 0
    ds_read_b128 v[108:111], v240 offset:32768
    s_waitcnt vmcnt(5)
    ds_write_b128 v244, v[24:27] offset:0
    s_waitcnt vmcnt(4)
    ds_write_b128 v244, v[28:31] offset:1024
    s_waitcnt lgkmcnt(4)
    v_mfma_f32_32x32x16_bf16 v[48:63], v[92:95], v[4:7], v[48:63]
    ds_read_b128 v[112:115], v240 offset:41984
    s_waitcnt vmcnt(3)
    ds_write_b128 v244, v[32:35] offset:2048
    s_waitcnt vmcnt(2)
    ds_write_b128 v244, v[36:39] offset:3072
    s_waitcnt lgkmcnt(6)
    v_mfma_f32_32x32x16_bf16 v[48:63], v[104:107], v[8:11], v[48:63]
    ds_read_b128 v[116:119], v240 offset:51200
    s_waitcnt vmcnt(1)
    ds_write_b128 v244, v[40:43] offset:4096
    s_waitcnt vmcnt(0)
    ds_write_b128 v244, v[44:47] offset:5120
    s_setprio 3
    v_cvt_pk_bf16_f32 v148, v64, v65
    v_cvt_pk_bf16_f32 v149, v66, v67
    v_cvt_pk_bf16_f32 v150, v68, v69
    v_cvt_pk_bf16_f32 v151, v70, v71
    s_setprio 0
    s_waitcnt lgkmcnt(8)
    v_mfma_f32_32x32x16_bf16 v[48:63], v[108:111], v[12:15], v[48:63]
    ds_read_b128 v[80:83], v240 offset:6144
    ds_read_b128 v[24:27], v243 offset:0
    ds_read_b128 v[28:31], v243 offset:32
    s_setprio 3
    v_cvt_pk_bf16_f32 v158, v72, v73
    v_cvt_pk_bf16_f32 v159, v74, v75
    v_cvt_pk_bf16_f32 v160, v76, v77
    v_cvt_pk_bf16_f32 v161, v78, v79
    s_setprio 0
    s_waitcnt lgkmcnt(8)
    v_mfma_f32_32x32x16_bf16 v[48:63], v[112:115], v[16:19], v[48:63]
    ds_read_b128 v[84:87], v240 offset:15360
    ds_read_b128 v[32:35], v243 offset:64
    ds_read_b128 v[36:39], v243 offset:96
    s_waitcnt lgkmcnt(8)
    v_mfma_f32_32x32x16_bf16 v[48:63], v[116:119], v[20:23], v[48:63]
    ds_read_b128 v[88:91], v240 offset:24576
    ds_read_b128 v[40:43], v245 offset:0
    ds_read_b128 v[44:47], v246 offset:0
    s_setprio 1
    s_waitcnt lgkmcnt(7)
    v_mfma_f32_32x32x16_bf16 v[64:79], v[24:27], v[80:83], 0
    ds_read_b128 v[92:95], v240 offset:33792
    s_waitcnt lgkmcnt(6)
    v_mfma_f32_32x32x16_bf16 v[64:79], v[28:31], v[84:87], v[64:79]
    ds_read_b128 v[104:107], v240 offset:43008
    s_waitcnt lgkmcnt(4)
    v_mfma_f32_32x32x16_bf16 v[64:79], v[32:35], v[88:91], v[64:79]
    ds_read_b128 v[108:111], v240 offset:52224
    s_setprio 3
    v_cvt_pk_bf16_f32 v162, v48, v49
    v_cvt_pk_bf16_f32 v163, v50, v51
    v_cvt_pk_bf16_f32 v170, v52, v53
    v_cvt_pk_bf16_f32 v171, v54, v55
    s_setprio 1
    s_waitcnt lgkmcnt(2)
    v_mfma_f32_32x32x16_bf16 v[64:79], v[36:39], v[92:95], v[64:79]
    ds_read_b128 v[112:115], v240 offset:7168
    s_setprio 3
    v_cvt_pk_bf16_f32 v172, v56, v57
    v_cvt_pk_bf16_f32 v173, v58, v59
    v_cvt_pk_bf16_f32 v174, v60, v61
    v_cvt_pk_bf16_f32 v175, v62, v63
    s_setprio 1
    s_waitcnt lgkmcnt(2)
    v_mfma_f32_32x32x16_bf16 v[64:79], v[40:43], v[104:107], v[64:79]
    ds_read_b128 v[116:119], v240 offset:16384
    s_waitcnt lgkmcnt(2)
    v_mfma_f32_32x32x16_bf16 v[64:79], v[44:47], v[108:111], v[64:79]
    ds_read_b128 v[80:83], v240 offset:25600
    s_waitcnt lgkmcnt(2)
    v_mfma_f32_32x32x16_bf16 v[48:63], v[24:27], v[112:115], 0
    ds_read_b128 v[84:87], v240 offset:34816
    s_waitcnt lgkmcnt(2)
    v_mfma_f32_32x32x16_bf16 v[48:63], v[28:31], v[116:119], v[48:63]
    ds_read_b128 v[88:91], v240 offset:44032
    s_waitcnt lgkmcnt(2)
    v_mfma_f32_32x32x16_bf16 v[48:63], v[32:35], v[80:83], v[48:63]
    ds_read_b128 v[92:95], v240 offset:53248
    s_setprio 3
    s_mov_b64 exec, s[52:53]
    v_cvt_pk_bf16_f32 v232, v64, v65
    v_cvt_pk_bf16_f32 v233, v66, v67
    s_not_b64 exec, exec
    v_cvt_pk_bf16_f32 v184, v64, v65
    v_cvt_pk_bf16_f32 v185, v66, v67
    s_mov_b64 exec, -1
    s_setprio 1
    s_waitcnt lgkmcnt(2)
    v_mfma_f32_32x32x16_bf16 v[48:63], v[36:39], v[84:87], v[48:63]
    ds_read_b128 v[104:107], v240 offset:8192
    s_setprio 3
    s_mov_b64 exec, s[52:53]
    v_cvt_pk_bf16_f32 v234, v68, v69
    v_cvt_pk_bf16_f32 v235, v70, v71
    s_not_b64 exec, exec
    v_cvt_pk_bf16_f32 v186, v68, v69
    v_cvt_pk_bf16_f32 v187, v70, v71
    s_mov_b64 exec, -1
    s_setprio 1
    s_waitcnt lgkmcnt(2)
    v_mfma_f32_32x32x16_bf16 v[48:63], v[40:43], v[88:91], v[48:63]
    ds_read_b128 v[108:111], v240 offset:17408
    s_setprio 3
    s_mov_b64 exec, s[52:53]
    v_cvt_pk_bf16_f32 v236, v72, v73
    v_cvt_pk_bf16_f32 v237, v74, v75
    s_not_b64 exec, exec
    v_cvt_pk_bf16_f32 v188, v72, v73
    v_cvt_pk_bf16_f32 v189, v74, v75
    s_mov_b64 exec, -1
    s_setprio 1
    s_waitcnt lgkmcnt(2)
    v_mfma_f32_32x32x16_bf16 v[48:63], v[44:47], v[92:95], v[48:63]
    ds_read_b128 v[112:115], v240 offset:26624
    s_setprio 3
    s_mov_b64 exec, s[52:53]
    v_cvt_pk_bf16_f32 v238, v76, v77
    v_cvt_pk_bf16_f32 v239, v78, v79
    s_not_b64 exec, exec
    v_cvt_pk_bf16_f32 v190, v76, v77
    v_cvt_pk_bf16_f32 v191, v78, v79
    s_mov_b64 exec, -1
    s_setprio 1
    s_waitcnt lgkmcnt(2)
    v_mfma_f32_32x32x16_bf16 v[64:79], v[24:27], v[104:107], 0
    ds_read_b128 v[116:119], v240 offset:35840
    s_waitcnt lgkmcnt(2)
    v_mfma_f32_32x32x16_bf16 v[64:79], v[28:31], v[108:111], v[64:79]
    ds_read_b128 v[80:83], v240 offset:45056
    s_waitcnt lgkmcnt(2)
    v_mfma_f32_32x32x16_bf16 v[64:79], v[32:35], v[112:115], v[64:79]
    ds_read_b128 v[84:87], v240 offset:54272
    s_setprio 3
    s_mov_b64 exec, s[54:55]
    v_cvt_pk_bf16_f32 v232, v48, v49
    v_cvt_pk_bf16_f32 v233, v50, v51
    s_not_b64 exec, exec
    v_cvt_pk_bf16_f32 v200, v48, v49
    v_cvt_pk_bf16_f32 v201, v50, v51
    s_mov_b64 exec, -1
    s_setprio 1
    s_waitcnt lgkmcnt(2)
    v_mfma_f32_32x32x16_bf16 v[64:79], v[36:39], v[116:119], v[64:79]
    ds_read_b128 v[88:91], v240 offset:3072
    s_setprio 3
    s_mov_b64 exec, s[54:55]
    v_cvt_pk_bf16_f32 v234, v52, v53
    v_cvt_pk_bf16_f32 v235, v54, v55
    s_not_b64 exec, exec
    v_cvt_pk_bf16_f32 v202, v52, v53
    v_cvt_pk_bf16_f32 v203, v54, v55
    s_mov_b64 exec, -1
    s_setprio 1
    s_waitcnt lgkmcnt(2)
    v_mfma_f32_32x32x16_bf16 v[64:79], v[40:43], v[80:83], v[64:79]
    ds_read_b128 v[92:95], v240 offset:12288
    s_setprio 3
    s_mov_b64 exec, s[54:55]
    v_cvt_pk_bf16_f32 v236, v56, v57
    v_cvt_pk_bf16_f32 v237, v58, v59
    s_not_b64 exec, exec
    v_cvt_pk_bf16_f32 v204, v56, v57
    v_cvt_pk_bf16_f32 v205, v58, v59
    s_mov_b64 exec, -1
    s_setprio 1
    s_waitcnt lgkmcnt(2)
    v_mfma_f32_32x32x16_bf16 v[64:79], v[44:47], v[84:87], v[64:79]
    ds_read_b128 v[104:107], v240 offset:21504
    s_setprio 3
    s_mov_b64 exec, s[54:55]
    v_cvt_pk_bf16_f32 v238, v60, v61
    v_cvt_pk_bf16_f32 v239, v62, v63
    s_not_b64 exec, exec
    v_cvt_pk_bf16_f32 v206, v60, v61
    v_cvt_pk_bf16_f32 v207, v62, v63
    s_mov_b64 exec, -1
    s_setprio 1
    s_waitcnt lgkmcnt(2)
    v_mfma_f32_32x32x16_bf16 v[48:63], v[88:91], v[24:27], 0
    ds_read_b128 v[108:111], v240 offset:30720
    s_waitcnt lgkmcnt(2)
    v_mfma_f32_32x32x16_bf16 v[48:63], v[92:95], v[28:31], v[48:63]
    ds_read_b128 v[112:115], v240 offset:39936
    s_waitcnt lgkmcnt(2)
    v_mfma_f32_32x32x16_bf16 v[48:63], v[104:107], v[32:35], v[48:63]
    ds_read_b128 v[116:119], v240 offset:49152
    s_setprio 3
    s_mov_b64 exec, s[56:57]
    v_cvt_pk_bf16_f32 v232, v64, v65
    v_cvt_pk_bf16_f32 v233, v66, v67
    s_not_b64 exec, exec
    v_cvt_pk_bf16_f32 v216, v64, v65
    v_cvt_pk_bf16_f32 v217, v66, v67
    s_mov_b64 exec, -1
    s_setprio 1
    s_waitcnt lgkmcnt(2)
    v_mfma_f32_32x32x16_bf16 v[48:63], v[108:111], v[36:39], v[48:63]
    ds_read_b128 v[80:83], v240 offset:4096
    s_setprio 3
    s_mov_b64 exec, s[56:57]
    v_cvt_pk_bf16_f32 v234, v68, v69
    v_cvt_pk_bf16_f32 v235, v70, v71
    s_not_b64 exec, exec
    v_cvt_pk_bf16_f32 v218, v68, v69
    v_cvt_pk_bf16_f32 v219, v70, v71
    s_mov_b64 exec, -1
    s_setprio 1
    s_waitcnt lgkmcnt(2)
    v_mfma_f32_32x32x16_bf16 v[48:63], v[112:115], v[40:43], v[48:63]
    ds_read_b128 v[84:87], v240 offset:13312
    s_setprio 3
    s_mov_b64 exec, s[56:57]
    v_cvt_pk_bf16_f32 v236, v72, v73
    v_cvt_pk_bf16_f32 v237, v74, v75
    s_not_b64 exec, exec
    v_cvt_pk_bf16_f32 v220, v72, v73
    v_cvt_pk_bf16_f32 v221, v74, v75
    s_mov_b64 exec, -1
    s_setprio 1
    s_waitcnt lgkmcnt(2)
    v_mfma_f32_32x32x16_bf16 v[48:63], v[116:119], v[44:47], v[48:63]
    ds_read_b128 v[88:91], v240 offset:22528
    s_setprio 3
    s_mov_b64 exec, s[56:57]
    v_cvt_pk_bf16_f32 v238, v76, v77
    v_cvt_pk_bf16_f32 v239, v78, v79
    s_not_b64 exec, exec
    v_cvt_pk_bf16_f32 v222, v76, v77
    v_cvt_pk_bf16_f32 v223, v78, v79
    s_mov_b64 exec, -1
    s_setprio 1
    s_waitcnt lgkmcnt(2)
    v_mfma_f32_32x32x16_bf16 v[64:79], v[80:83], v[24:27], 0
    ds_read_b128 v[92:95], v240 offset:31744
    s_waitcnt lgkmcnt(2)
    v_mfma_f32_32x32x16_bf16 v[64:79], v[84:87], v[28:31], v[64:79]
    ds_read_b128 v[104:107], v240 offset:40960
    s_waitcnt lgkmcnt(2)
    v_mfma_f32_32x32x16_bf16 v[64:79], v[88:91], v[32:35], v[64:79]
    ds_read_b128 v[108:111], v240 offset:50176
    s_setprio 3
    v_cvt_pk_bf16_f32 v128, v48, v49
    v_cvt_pk_bf16_f32 v129, v50, v51
    v_cvt_pk_bf16_f32 v130, v52, v53
    v_cvt_pk_bf16_f32 v131, v54, v55
    s_setprio 1
    s_waitcnt lgkmcnt(2)
    v_mfma_f32_32x32x16_bf16 v[64:79], v[92:95], v[36:39], v[64:79]
    ds_read_b128 v[112:115], v240 offset:5120
    s_setprio 3
    v_cvt_pk_bf16_f32 v132, v56, v57
    v_cvt_pk_bf16_f32 v133, v58, v59
    v_cvt_pk_bf16_f32 v140, v60, v61
    v_cvt_pk_bf16_f32 v141, v62, v63
    s_setprio 1
    s_waitcnt lgkmcnt(2)
    v_mfma_f32_32x32x16_bf16 v[64:79], v[104:107], v[40:43], v[64:79]
    ds_read_b128 v[116:119], v240 offset:14336
    s_waitcnt lgkmcnt(2)
    v_mfma_f32_32x32x16_bf16 v[64:79], v[108:111], v[44:47], v[64:79]
    ds_read_b128 v[80:83], v240 offset:23552
    s_waitcnt lgkmcnt(2)
    v_mfma_f32_32x32x16_bf16 v[48:63], v[112:115], v[24:27], 0
    ds_read_b128 v[84:87], v240 offset:32768
    s_waitcnt lgkmcnt(2)
    v_mfma_f32_32x32x16_bf16 v[48:63], v[116:119], v[28:31], v[48:63]
    ds_read_b128 v[88:91], v240 offset:41984
    s_waitcnt lgkmcnt(2)
    v_mfma_f32_32x32x16_bf16 v[48:63], v[80:83], v[32:35], v[48:63]
    ds_read_b128 v[92:95], v240 offset:51200
    s_setprio 3
    s_nop 0
    v_cvt_pk_bf16_f32 v142, v64, v65
    v_cvt_pk_bf16_f32 v143, v66, v67
    v_cvt_pk_bf16_f32 v144, v68, v69
    v_cvt_pk_bf16_f32 v145, v70, v71
    s_setprio 1
    s_cmp_ge_u32 s36, 4
    s_cbranch_scc1 L_nobarB
    s_barrier
L_nobarB:
    s_waitcnt lgkmcnt(2)
    v_mfma_f32_32x32x16_bf16 v[48:63], v[84:87], v[36:39], v[48:63]
    s_setprio 3
    v_cvt_pk_bf16_f32 v152, v72, v73
    v_cvt_pk_bf16_f32 v153, v74, v75
    v_cvt_pk_bf16_f32 v154, v76, v77
    v_cvt_pk_bf16_f32 v155, v78, v79
    s_setprio 1
    ds_read_b128 v[96:99], v240 offset:0
    s_waitcnt lgkmcnt(2)
    v_mfma_f32_32x32x16_bf16 v[48:63], v[88:91], v[40:43], v[48:63]
    ds_read_b128 v[100:103], v240 offset:9216
    s_waitcnt lgkmcnt(2)
    v_mfma_f32_32x32x16_bf16 v[48:63], v[92:95], v[44:47], v[48:63]
    ds_read_b128 v[120:123], v240 offset:18432
    s_waitcnt lgkmcnt(2)
    v_mfma_f32_32x32x16_bf16 v[80:95], v[96:99], v[0:3], 0
    ds_read_b128 v[124:127], v240 offset:27648
    v_mfma_f32_32x32x16_bf16 v[104:119], v[96:99], v[24:27], 0
    s_waitcnt lgkmcnt(2)
    v_mfma_f32_32x32x16_bf16 v[80:95], v[100:103], v[4:7], v[80:95]
    ds_read_b128 v[96:99], v240 offset:36864
    v_mfma_f32_32x32x16_bf16 v[104:119], v[100:103], v[28:31], v[104:119]
    s_setprio 3
    s_nop 1
    v_cvt_pk_bf16_f32 v156, v48, v49
    v_cvt_pk_bf16_f32 v157, v50, v51
    v_cvt_pk_bf16_f32 v164, v52, v53
    v_cvt_pk_bf16_f32 v165, v54, v55
    s_setprio 1
    s_waitcnt lgkmcnt(2)
    v_mfma_f32_32x32x16_bf16 v[80:95], v[120:123], v[8:11], v[80:95]
    ds_read_b128 v[100:103], v240 offset:46080
    v_mfma_f32_32x32x16_bf16 v[104:119], v[120:123], v[32:35], v[104:119]
    s_setprio 3
    v_cvt_pk_bf16_f32 v166, v56, v57
    v_cvt_pk_bf16_f32 v167, v58, v59
    v_cvt_pk_bf16_f32 v168, v60, v61
    v_cvt_pk_bf16_f32 v169, v62, v63
    s_setprio 1
    s_waitcnt lgkmcnt(2)
    v_mfma_f32_32x32x16_bf16 v[80:95], v[124:127], v[12:15], v[80:95]
    ds_read_b128 v[120:123], v240 offset:1024
    v_mfma_f32_32x32x16_bf16 v[104:119], v[124:127], v[36:39], v[104:119]
    s_waitcnt lgkmcnt(2)
    v_mfma_f32_32x32x16_bf16 v[80:95], v[96:99], v[16:19], v[80:95]
    ds_read_b128 v[124:127], v240 offset:10240
    v_mfma_f32_32x32x16_bf16 v[104:119], v[96:99], v[40:43], v[104:119]
    s_waitcnt lgkmcnt(2)
    v_mfma_f32_32x32x16_bf16 v[80:95], v[100:103], v[20:23], v[80:95]
    ds_read_b128 v[96:99], v240 offset:19456
    v_mfma_f32_32x32x16_bf16 v[104:119], v[100:103], v[44:47], v[104:119]
    s_waitcnt lgkmcnt(2)
    v_mfma_f32_32x32x16_bf16 v[48:63], v[120:123], v[0:3], 0
    ds_read_b128 v[100:103], v240 offset:28672
    v_mfma_f32_32x32x16_bf16 v[64:79], v[120:123], v[24:27], 0
    s_waitcnt lgkmcnt(2)
    v_mfma_f32_32x32x16_bf16 v[48:63], v[124:127], v[4:7], v[48:63]
    ds_read_b128 v[120:123], v240 offset:37888
    v_mfma_f32_32x32x16_bf16 v[64:79], v[124:127], v[28:31], v[64:79]
    s_setprio 3
    s_nop 0
    v_cvt_pk_bf16_f32 v80, v80, v81
    v_cvt_pk_bf16_f32 v81, v82, v83
    v_cvt_pk_bf16_f32 v82, v84, v85
    v_cvt_pk_bf16_f32 v83, v86, v87
    s_setprio 1
    s_waitcnt lgkmcnt(2)
    v_mfma_f32_32x32x16_bf16 v[48:63], v[96:99], v[8:11], v[48:63]
    ds_read_b128 v[124:127], v240 offset:47104
    v_mfma_f32_32x32x16_bf16 v[64:79], v[96:99], v[32:35], v[64:79]
    s_setprio 3
    v_cvt_pk_bf16_f32 v84, v88, v89
    v_cvt_pk_bf16_f32 v85, v90, v91
    v_cvt_pk_bf16_f32 v86, v92, v93
    v_cvt_pk_bf16_f32 v87, v94, v95
    s_setprio 1
    s_waitcnt lgkmcnt(2)
    v_mfma_f32_32x32x16_bf16 v[48:63], v[100:103], v[12:15], v[48:63]
    ds_read_b128 v[96:99], v240 offset:2048
    v_mfma_f32_32x32x16_bf16 v[64:79], v[100:103], v[36:39], v[64:79]
    s_setprio 3
    v_cvt_pk_bf16_f32 v104, v104, v105
    v_cvt_pk_bf16_f32 v105, v106, v107
    v_cvt_pk_bf16_f32 v106, v108, v109
    v_cvt_pk_bf16_f32 v107, v110, v111
    s_setprio 1
    s_waitcnt lgkmcnt(2)
    v_mfma_f32_32x32x16_bf16 v[48:63], v[120:123], v[16:19], v[48:63]
    ds_read_b128 v[100:103], v240 offset:11264
    v_mfma_f32_32x32x16_bf16 v[64:79], v[120:123], v[40:43], v[64:79]
    s_setprio 3
    v_cvt_pk_bf16_f32 v108, v112, v113
    v_cvt_pk_bf16_f32 v109, v114, v115
    v_cvt_pk_bf16_f32 v110, v116, v117
    v_cvt_pk_bf16_f32 v111, v118, v119
    s_setprio 1
    s_waitcnt lgkmcnt(2)
    v_mfma_f32_32x32x16_bf16 v[48:63], v[124:127], v[20:23], v[48:63]
    ds_read_b128 v[120:123], v240 offset:20480
    v_mfma_f32_32x32x16_bf16 v[64:79], v[124:127], v[44:47], v[64:79]
    s_setprio 3
    s_nop 8
    v_cvt_pk_bf16_f32 v88, v48, v49
    v_cvt_pk_bf16_f32 v89, v50, v51
    v_cvt_pk_bf16_f32 v90, v52, v53
    v_cvt_pk_bf16_f32 v91, v54, v55
    v_cvt_pk_bf16_f32 v92, v56, v57
    v_cvt_pk_bf16_f32 v93, v58, v59
    v_cvt_pk_bf16_f32 v94, v60, v61
    v_cvt_pk_bf16_f32 v95, v62, v63
    v_cvt_pk_bf16_f32 v112, v64, v65
    v_cvt_pk_bf16_f32 v113, v66, v67
    v_cvt_pk_bf16_f32 v114, v68, v69
    v_cvt_pk_bf16_f32 v115, v70, v71
    v_cvt_pk_bf16_f32 v116, v72, v73
    v_cvt_pk_bf16_f32 v117, v74, v75
    v_cvt_pk_bf16_f32 v118, v76, v77
    v_cvt_pk_bf16_f32 v119, v78, v79
    s_setprio 1
    s_waitcnt lgkmcnt(2)
    v_mfma_f32_32x32x16_bf16 v[48:63], v[96:99], v[0:3], 0
    ds_read_b128 v[124:127], v240 offset:29696
    v_mfma_f32_32x32x16_bf16 v[64:79], v[96:99], v[24:27], 0
    s_waitcnt lgkmcnt(2)
    v_mfma_f32_32x32x16_bf16 v[48:63], v[100:103], v[4:7], v[48:63]
    ds_read_b128 v[96:99], v240 offset:38912
    v_mfma_f32_32x32x16_bf16 v[64:79], v[100:103], v[28:31], v[64:79]
    s_waitcnt lgkmcnt(2)
    v_mfma_f32_32x32x16_bf16 v[48:63], v[120:123], v[8:11], v[48:63]
    ds_read_b128 v[100:103], v240 offset:48128
    v_mfma_f32_32x32x16_bf16 v[64:79], v[120:123], v[32:35], v[64:79]
    s_waitcnt lgkmcnt(2)
    v_mfma_f32_32x32x16_bf16 v[48:63], v[124:127], v[12:15], v[48:63]
    v_mfma_f32_32x32x16_bf16 v[64:79], v[124:127], v[36:39], v[64:79]
    s_waitcnt lgkmcnt(1)
    v_mfma_f32_32x32x16_bf16 v[48:63], v[96:99], v[16:19], v[48:63]
    ds_read_b128 v[0:3], v242 offset:1152
    ds_read_b128 v[4:7], v242 offset:768
    ds_read_b128 v[8:11], v242 offset:384
    ds_read_b128 v[12:15], v242 offset:0
    v_mfma_f32_32x32x16_bf16 v[64:79], v[96:99], v[40:43], v[64:79]
    s_waitcnt lgkmcnt(4)
    v_mfma_f32_32x32x16_bf16 v[48:63], v[100:103], v[20:23], v[48:63]
    v_mfma_f32_32x32x16_bf16 v[64:79], v[100:103], v[44:47], v[64:79]
    s_setprio 2
    ds_read_b128 v[16:19], v241 offset:2688
    ds_read_b128 v[20:23], v241 offset:2304
    ds_read_b128 v[24:27], v241 offset:1920
    ds_read_b128 v[28:31], v241 offset:1536
    s_waitcnt lgkmcnt(4)
    v_mfma_f32_32x32x16_bf16 v[0:15], v[128:131], v[80:83], v[0:15]
    s_nop 3
    v_cvt_pk_bf16_f32 v96, v48, v49
    v_cvt_pk_bf16_f32 v97, v50, v51
    v_cvt_pk_bf16_f32 v98, v52, v53
    v_cvt_pk_bf16_f32 v99, v54, v55
    v_mfma_f32_32x32x8_bf16 v[0:15], v[132:133], v[84:85], v[0:15]
    v_cvt_pk_bf16_f32 v100, v56, v57
    v_cvt_pk_bf16_f32 v101, v58, v59
    v_cvt_pk_bf16_f32 v102, v60, v61
    v_cvt_pk_bf16_f32 v103, v62, v63
    v_cvt_pk_bf16_f32 v120, v64, v65
    v_cvt_pk_bf16_f32 v121, v66, v67
    v_cvt_pk_bf16_f32 v122, v68, v69
    v_cvt_pk_bf16_f32 v123, v70, v71
    v_cvt_pk_bf16_f32 v124, v72, v73
    v_cvt_pk_bf16_f32 v125, v74, v75
    v_cvt_pk_bf16_f32 v126, v76, v77
    v_cvt_pk_bf16_f32 v127, v78, v79
    v_exp_f32_e32 v0, v0
    v_exp_f32_e32 v1, v1
    v_exp_f32_e32 v2, v2
    s_waitcnt lgkmcnt(0)
    v_mfma_f32_32x32x16_bf16 v[32:47], v[128:131], v[104:107], v[16:31]
    v_exp_f32_e32 v3, v3
    v_cvt_pk_bf16_f32 v0, v0, v1
    v_exp_f32_e32 v4, v4
    v_exp_f32_e32 v5, v5
    v_cvt_pk_bf16_f32 v1, v2, v3
    v_mfma_f32_32x32x16_bf16 v[16:31], v[134:137], v[80:83], v[16:31]
    v_exp_f32_e32 v6, v6
    v_exp_f32_e32 v7, v7
    v_cvt_pk_bf16_f32 v2, v4, v5
    v_exp_f32_e32 v8, v8
    v_exp_f32_e32 v9, v9
    v_mfma_f32_32x32x8_bf16 v[16:31], v[138:139], v[84:85], v[16:31]
    v_cvt_pk_bf16_f32 v3, v6, v7
    v_exp_f32_e32 v10, v10
    v_exp_f32_e32 v11, v11
    v_cvt_pk_bf16_f32 v4, v8, v9
    v_exp_f32_e32 v12, v12
    v_exp_f32_e32 v13, v13
    v_cvt_pk_bf16_f32 v5, v10, v11
    v_exp_f32_e32 v14, v14
    v_exp_f32_e32 v15, v15
    v_cvt_pk_bf16_f32 v6, v12, v13
    v_cvt_pk_bf16_f32 v7, v14, v15
    v_mfma_f32_32x32x16_bf16 v[64:79], v[184:187], v[0:3], 0
    ds_read_b128 v[48:51], v242 offset:4224
    ds_read_b128 v[52:55], v242 offset:3840
    v_exp_f32_e32 v16, v16
    v_exp_f32_e32 v17, v17
    v_exp_f32_e32 v18, v18
    v_exp_f32_e32 v19, v19
    v_cvt_pk_bf16_f32 v16, v16, v17
    v_exp_f32_e32 v20, v20
    v_mfma_f32_32x32x16_bf16 v[64:79], v[188:191], v[4:7], v[64:79]
    ds_read_b128 v[56:59], v242 offset:3456
    ds_read_b128 v[60:63], v242 offset:3072
    v_exp_f32_e32 v21, v21
    v_cvt_pk_bf16_f32 v17, v18, v19
    v_exp_f32_e32 v22, v22
    v_exp_f32_e32 v23, v23
    v_cvt_pk_bf16_f32 v18, v20, v21
    v_exp_f32_e32 v24, v24
    v_mfma_f32_32x32x8_bf16 v[32:47], v[132:133], v[108:109], v[32:47]
    v_exp_f32_e32 v25, v25
    v_cvt_pk_bf16_f32 v19, v22, v23
    v_exp_f32_e32 v26, v26
    v_exp_f32_e32 v27, v27
    v_cvt_pk_bf16_f32 v20, v24, v25
    v_exp_f32_e32 v28, v28
    v_exp_f32_e32 v29, v29
    v_cvt_pk_bf16_f32 v21, v26, v27
    v_exp_f32_e32 v30, v30
    v_exp_f32_e32 v31, v31
    v_cvt_pk_bf16_f32 v22, v28, v29
    v_cvt_pk_bf16_f32 v23, v30, v31
    v_mfma_f32_32x32x16_bf16 v[64:79], v[176:179], v[16:19], v[64:79]
    ds_read_b128 v[0:3], v242 offset:1344
    v_exp_f32_e32 v32, v32
    v_exp_f32_e32 v33, v33
    v_exp_f32_e32 v34, v34
    v_exp_f32_e32 v35, v35
    v_cvt_pk_bf16_f32 v32, v32, v33
    v_mfma_f32_32x32x16_bf16 v[64:79], v[180:183], v[20:23], v[64:79]
    ds_read_b128 v[4:7], v242 offset:960
    v_exp_f32_e32 v36, v36
    v_exp_f32_e32 v37, v37
    v_cvt_pk_bf16_f32 v33, v34, v35
    v_exp_f32_e32 v38, v38
    v_exp_f32_e32 v39, v39
    s_waitcnt lgkmcnt(2)
    v_mfma_f32_32x32x16_bf16 v[48:63], v[134:137], v[104:107], v[48:63]
    ds_read_b128 v[8:11], v242 offset:576
    v_cvt_pk_bf16_f32 v34, v36, v37
    v_exp_f32_e32 v40, v40
    v_exp_f32_e32 v41, v41
    v_cvt_pk_bf16_f32 v35, v38, v39
    v_exp_f32_e32 v42, v42
    v_mfma_f32_32x32x8_bf16 v[48:63], v[138:139], v[108:109], v[48:63]
    ds_read_b128 v[12:15], v242 offset:192
    v_exp_f32_e32 v43, v43
    v_cvt_pk_bf16_f32 v36, v40, v41
    v_exp_f32_e32 v44, v44
    v_exp_f32_e32 v45, v45
    v_cvt_pk_bf16_f32 v37, v42, v43
    v_exp_f32_e32 v46, v46
    v_exp_f32_e32 v47, v47
    v_cvt_pk_bf16_f32 v38, v44, v45
    v_rcp_f32_e32 v252, v64
    v_cvt_pk_bf16_f32 v39, v46, v47
    v_mul_f32_e32 v68, v68, v252
    v_mul_f32_e32 v69, v69, v252
    v_mul_f32_e32 v70, v70, v252
    v_mul_f32_e32 v71, v71, v252
    v_mul_f32_e32 v72, v72, v252
    v_mul_f32_e32 v73, v73, v252
    v_mul_f32_e32 v74, v74, v252
    v_mul_f32_e32 v75, v75, v252
    v_mul_f32_e32 v76, v76, v252
    v_mul_f32_e32 v77, v77, v252
    v_mul_f32_e32 v78, v78, v252
    v_mul_f32_e32 v79, v79, v252
    v_max_f32_e64 v250, v64, v252
    v_cvt_pk_bf16_f32 v80, v68, v69
    v_cvt_pk_bf16_f32 v81, v70, v71
    v_cvt_pk_bf16_f32 v82, v72, v73
    v_cvt_pk_bf16_f32 v83, v74, v75
    v_cvt_pk_bf16_f32 v84, v76, v77
    v_cvt_pk_bf16_f32 v85, v78, v79
    v_mfma_f32_32x32x16_bf16 v[64:79], v[184:187], v[32:35], 0
    ds_read_b128 v[16:19], v241 offset:2880
    v_exp_f32_e32 v48, v48
    v_exp_f32_e32 v49, v49
    v_exp_f32_e32 v50, v50
    v_exp_f32_e32 v51, v51
    v_cvt_pk_bf16_f32 v48, v48, v49
    v_mfma_f32_32x32x16_bf16 v[64:79], v[188:191], v[36:39], v[64:79]
    ds_read_b128 v[20:23], v241 offset:2496
    v_exp_f32_e32 v52, v52
    v_exp_f32_e32 v53, v53
    v_cvt_pk_bf16_f32 v49, v50, v51
    v_exp_f32_e32 v54, v54
    v_exp_f32_e32 v55, v55
    s_waitcnt lgkmcnt(2)
    v_mfma_f32_32x32x16_bf16 v[0:15], v[140:143], v[86:89], v[0:15]
    ds_read_b128 v[24:27], v241 offset:2112
    v_cvt_pk_bf16_f32 v50, v52, v53
    v_exp_f32_e32 v56, v56
    v_exp_f32_e32 v57, v57
    v_cvt_pk_bf16_f32 v51, v54, v55
    v_exp_f32_e32 v58, v58
    v_mfma_f32_32x32x8_bf16 v[0:15], v[144:145], v[90:91], v[0:15]
    ds_read_b128 v[28:31], v241 offset:1728
    v_exp_f32_e32 v59, v59
    v_cvt_pk_bf16_f32 v52, v56, v57
    v_exp_f32_e32 v60, v60
    v_exp_f32_e32 v61, v61
    v_cvt_pk_bf16_f32 v53, v58, v59
    v_exp_f32_e32 v62, v62
    v_exp_f32_e32 v63, v63
    v_cvt_pk_bf16_f32 v54, v60, v61
    v_cvt_pk_bf16_f32 v55, v62, v63
    v_mfma_f32_32x32x16_bf16 v[64:79], v[176:179], v[48:51], v[64:79]
    s_nop 0
    v_exp_f32_e32 v0, v0
    v_exp_f32_e32 v1, v1
    v_exp_f32_e32 v2, v2
    v_exp_f32_e32 v3, v3
    v_mfma_f32_32x32x16_bf16 v[64:79], v[180:183], v[52:55], v[64:79]
    v_cvt_pk_bf16_f32 v0, v0, v1
    v_exp_f32_e32 v4, v4
    v_exp_f32_e32 v5, v5
    v_cvt_pk_bf16_f32 v1, v2, v3
    s_waitcnt lgkmcnt(0)
    v_mfma_f32_32x32x16_bf16 v[32:47], v[140:143], v[110:113], v[16:31]
    v_exp_f32_e32 v6, v6
    v_exp_f32_e32 v7, v7
    v_cvt_pk_bf16_f32 v2, v4, v5
    v_exp_f32_e32 v8, v8
    v_mfma_f32_32x32x16_bf16 v[16:31], v[146:149], v[86:89], v[16:31]
    v_exp_f32_e32 v9, v9
    v_cvt_pk_bf16_f32 v3, v6, v7
    v_exp_f32_e32 v10, v10
    v_exp_f32_e32 v11, v11
    v_mfma_f32_32x32x8_bf16 v[16:31], v[150:151], v[90:91], v[16:31]
    v_cvt_pk_bf16_f32 v4, v8, v9
    v_exp_f32_e32 v12, v12
    v_exp_f32_e32 v13, v13
    v_cvt_pk_bf16_f32 v5, v10, v11
    v_exp_f32_e32 v14, v14
    v_exp_f32_e32 v15, v15
    v_cvt_pk_bf16_f32 v6, v12, v13
    v_rcp_f32_e32 v252, v64
    v_cvt_pk_bf16_f32 v7, v14, v15
    v_mul_f32_e32 v68, v68, v252
    v_mul_f32_e32 v69, v69, v252
    v_mul_f32_e32 v70, v70, v252
    v_mul_f32_e32 v71, v71, v252
    v_mul_f32_e32 v72, v72, v252
    v_mul_f32_e32 v73, v73, v252
    v_mul_f32_e32 v74, v74, v252
    v_mul_f32_e32 v75, v75, v252
    v_mul_f32_e32 v76, v76, v252
    v_mul_f32_e32 v77, v77, v252
    v_mul_f32_e32 v78, v78, v252
    v_mul_f32_e32 v79, v79, v252
    v_max3_f32 v250, v250, v64, v252
    v_cvt_pk_bf16_f32 v104, v68, v69
    v_cvt_pk_bf16_f32 v105, v70, v71
    v_cvt_pk_bf16_f32 v106, v72, v73
    v_cvt_pk_bf16_f32 v107, v74, v75
    v_cvt_pk_bf16_f32 v108, v76, v77
    v_cvt_pk_bf16_f32 v109, v78, v79
    v_mfma_f32_32x32x16_bf16 v[64:79], v[200:203], v[0:3], 0
    ds_read_b128 v[48:51], v242 offset:4416
    ds_read_b128 v[52:55], v242 offset:4032
    v_exp_f32_e32 v16, v16
    v_exp_f32_e32 v17, v17
    v_exp_f32_e32 v18, v18
    v_exp_f32_e32 v19, v19
    v_cvt_pk_bf16_f32 v16, v16, v17
    v_exp_f32_e32 v20, v20
    v_mfma_f32_32x32x16_bf16 v[64:79], v[204:207], v[4:7], v[64:79]
    ds_read_b128 v[56:59], v242 offset:3648
    ds_read_b128 v[60:63], v242 offset:3264
    v_exp_f32_e32 v21, v21
    v_cvt_pk_bf16_f32 v17, v18, v19
    v_exp_f32_e32 v22, v22
    v_exp_f32_e32 v23, v23
    v_cvt_pk_bf16_f32 v18, v20, v21
    v_exp_f32_e32 v24, v24
    v_mfma_f32_32x32x8_bf16 v[32:47], v[144:145], v[114:115], v[32:47]
    v_exp_f32_e32 v25, v25
    v_cvt_pk_bf16_f32 v19, v22, v23
    v_exp_f32_e32 v26, v26
    v_exp_f32_e32 v27, v27
    v_cvt_pk_bf16_f32 v20, v24, v25
    v_exp_f32_e32 v28, v28
    v_exp_f32_e32 v29, v29
    v_cvt_pk_bf16_f32 v21, v26, v27
    v_exp_f32_e32 v30, v30
    v_exp_f32_e32 v31, v31
    v_cvt_pk_bf16_f32 v22, v28, v29
    v_cvt_pk_bf16_f32 v23, v30, v31
    v_mfma_f32_32x32x16_bf16 v[64:79], v[192:195], v[16:19], v[64:79]
    ds_read_b128 v[128:131], v242 offset:6912
    v_exp_f32_e32 v32, v32
    v_exp_f32_e32 v33, v33
    v_exp_f32_e32 v34, v34
    v_exp_f32_e32 v35, v35
    v_cvt_pk_bf16_f32 v32, v32, v33
    v_mfma_f32_32x32x16_bf16 v[64:79], v[196:199], v[20:23], v[64:79]
    ds_read_b128 v[132:135], v242 offset:6528
    v_exp_f32_e32 v36, v36
    v_exp_f32_e32 v37, v37
    v_cvt_pk_bf16_f32 v33, v34, v35
    v_exp_f32_e32 v38, v38
    v_exp_f32_e32 v39, v39
    s_waitcnt lgkmcnt(2)
    v_mfma_f32_32x32x16_bf16 v[48:63], v[146:149], v[110:113], v[48:63]
    ds_read_b128 v[136:139], v242 offset:6144
    v_cvt_pk_bf16_f32 v34, v36, v37
    v_exp_f32_e32 v40, v40
    v_exp_f32_e32 v41, v41
    v_cvt_pk_bf16_f32 v35, v38, v39
    v_exp_f32_e32 v42, v42
    v_mfma_f32_32x32x8_bf16 v[48:63], v[150:151], v[114:115], v[48:63]
    ds_read_b128 v[140:143], v242 offset:5760
    v_exp_f32_e32 v43, v43
    v_cvt_pk_bf16_f32 v36, v40, v41
    v_exp_f32_e32 v44, v44
    v_exp_f32_e32 v45, v45
    v_cvt_pk_bf16_f32 v37, v42, v43
    v_exp_f32_e32 v46, v46
    v_exp_f32_e32 v47, v47
    v_cvt_pk_bf16_f32 v38, v44, v45
    v_rcp_f32_e32 v252, v68
    v_cvt_pk_bf16_f32 v39, v46, v47
    v_mul_f32_e32 v64, v64, v252
    v_mul_f32_e32 v65, v65, v252
    v_mul_f32_e32 v66, v66, v252
    v_mul_f32_e32 v67, v67, v252
    v_mul_f32_e32 v72, v72, v252
    v_mul_f32_e32 v73, v73, v252
    v_mul_f32_e32 v74, v74, v252
    v_mul_f32_e32 v75, v75, v252
    v_mul_f32_e32 v76, v76, v252
    v_mul_f32_e32 v77, v77, v252
    v_mul_f32_e32 v78, v78, v252
    v_mul_f32_e32 v79, v79, v252
    v_max3_f32 v250, v250, v68, v252
    v_cvt_pk_bf16_f32 v86, v64, v65
    v_cvt_pk_bf16_f32 v87, v66, v67
    v_cvt_pk_bf16_f32 v88, v72, v73
    v_cvt_pk_bf16_f32 v89, v74, v75
    v_cvt_pk_bf16_f32 v90, v76, v77
    v_cvt_pk_bf16_f32 v91, v78, v79
    v_mfma_f32_32x32x16_bf16 v[64:79], v[200:203], v[32:35], 0
    ds_read_b128 v[16:19], v241 offset:8448
    v_exp_f32_e32 v48, v48
    v_exp_f32_e32 v49, v49
    v_exp_f32_e32 v50, v50
    v_exp_f32_e32 v51, v51
    v_cvt_pk_bf16_f32 v48, v48, v49
    v_mfma_f32_32x32x16_bf16 v[64:79], v[204:207], v[36:39], v[64:79]
    ds_read_b128 v[20:23], v241 offset:8064
    v_exp_f32_e32 v52, v52
    v_exp_f32_e32 v53, v53
    v_cvt_pk_bf16_f32 v49, v50, v51
    v_exp_f32_e32 v54, v54
    v_exp_f32_e32 v55, v55
    s_waitcnt lgkmcnt(2)
    v_mfma_f32_32x32x16_bf16 v[128:143], v[152:155], v[92:95], v[128:143]
    ds_read_b128 v[24:27], v241 offset:7680
    v_cvt_pk_bf16_f32 v50, v52, v53
    v_exp_f32_e32 v56, v56
    v_exp_f32_e32 v57, v57
    v_cvt_pk_bf16_f32 v51, v54, v55
    v_exp_f32_e32 v58, v58
    v_mfma_f32_32x32x8_bf16 v[128:143], v[156:157], v[96:97], v[128:143]
    ds_read_b128 v[28:31], v241 offset:7296
    v_exp_f32_e32 v59, v59
    v_cvt_pk_bf16_f32 v52, v56, v57
    v_exp_f32_e32 v60, v60
    v_exp_f32_e32 v61, v61
    v_cvt_pk_bf16_f32 v53, v58, v59
    v_exp_f32_e32 v62, v62
    v_exp_f32_e32 v63, v63
    v_cvt_pk_bf16_f32 v54, v60, v61
    v_cvt_pk_bf16_f32 v55, v62, v63
    v_mfma_f32_32x32x16_bf16 v[64:79], v[192:195], v[48:51], v[64:79]
    s_nop 0
    v_exp_f32_e32 v128, v128
    v_exp_f32_e32 v129, v129
    v_exp_f32_e32 v130, v130
    v_exp_f32_e32 v131, v131
    v_mfma_f32_32x32x16_bf16 v[64:79], v[196:199], v[52:55], v[64:79]
    v_cvt_pk_bf16_f32 v128, v128, v129
    v_exp_f32_e32 v132, v132
    v_exp_f32_e32 v133, v133
    v_cvt_pk_bf16_f32 v129, v130, v131
    s_waitcnt lgkmcnt(0)
    v_mfma_f32_32x32x16_bf16 v[32:47], v[152:155], v[116:119], v[16:31]
    v_exp_f32_e32 v134, v134
    v_exp_f32_e32 v135, v135
    v_cvt_pk_bf16_f32 v130, v132, v133
    v_exp_f32_e32 v136, v136
    v_mfma_f32_32x32x16_bf16 v[16:31], v[158:161], v[92:95], v[16:31]
    v_exp_f32_e32 v137, v137
    v_cvt_pk_bf16_f32 v131, v134, v135
    v_exp_f32_e32 v138, v138
    v_exp_f32_e32 v139, v139
    v_mfma_f32_32x32x8_bf16 v[16:31], v[162:163], v[96:97], v[16:31]
    v_cvt_pk_bf16_f32 v132, v136, v137
    v_exp_f32_e32 v140, v140
    v_exp_f32_e32 v141, v141
    v_cvt_pk_bf16_f32 v133, v138, v139
    v_exp_f32_e32 v142, v142
    v_exp_f32_e32 v143, v143
    v_cvt_pk_bf16_f32 v134, v140, v141
    v_rcp_f32_e32 v252, v68
    v_cvt_pk_bf16_f32 v135, v142, v143
    v_mul_f32_e32 v64, v64, v252
    v_mul_f32_e32 v65, v65, v252
    v_mul_f32_e32 v66, v66, v252
    v_mul_f32_e32 v67, v67, v252
    v_mul_f32_e32 v72, v72, v252
    v_mul_f32_e32 v73, v73, v252
    v_mul_f32_e32 v74, v74, v252
    v_mul_f32_e32 v75, v75, v252
    v_mul_f32_e32 v76, v76, v252
    v_mul_f32_e32 v77, v77, v252
    v_mul_f32_e32 v78, v78, v252
    v_mul_f32_e32 v79, v79, v252
    v_max3_f32 v250, v250, v68, v252
    v_cvt_pk_bf16_f32 v110, v64, v65
    v_cvt_pk_bf16_f32 v111, v66, v67
    v_cvt_pk_bf16_f32 v112, v72, v73
    v_cvt_pk_bf16_f32 v113, v74, v75
    v_cvt_pk_bf16_f32 v114, v76, v77
    v_cvt_pk_bf16_f32 v115, v78, v79
    v_mfma_f32_32x32x16_bf16 v[64:79], v[216:219], v[128:131], 0
    ds_read_b128 v[48:51], v242 offset:9984
    ds_read_b128 v[52:55], v242 offset:9600
    v_exp_f32_e32 v16, v16
    v_exp_f32_e32 v17, v17
    v_exp_f32_e32 v18, v18
    v_exp_f32_e32 v19, v19
    v_cvt_pk_bf16_f32 v16, v16, v17
    v_exp_f32_e32 v20, v20
    v_mfma_f32_32x32x16_bf16 v[64:79], v[220:223], v[132:135], v[64:79]
    ds_read_b128 v[56:59], v242 offset:9216
    ds_read_b128 v[60:63], v242 offset:8832
    v_exp_f32_e32 v21, v21
    v_cvt_pk_bf16_f32 v17, v18, v19
    v_exp_f32_e32 v22, v22
    v_exp_f32_e32 v23, v23
    v_cvt_pk_bf16_f32 v18, v20, v21
    v_exp_f32_e32 v24, v24
    v_mfma_f32_32x32x8_bf16 v[32:47], v[156:157], v[120:121], v[32:47]
    v_exp_f32_e32 v25, v25
    v_cvt_pk_bf16_f32 v19, v22, v23
    v_exp_f32_e32 v26, v26
    v_exp_f32_e32 v27, v27
    v_cvt_pk_bf16_f32 v20, v24, v25
    v_exp_f32_e32 v28, v28
    v_exp_f32_e32 v29, v29
    v_cvt_pk_bf16_f32 v21, v26, v27
    v_exp_f32_e32 v30, v30
    v_exp_f32_e32 v31, v31
    v_cvt_pk_bf16_f32 v22, v28, v29
    v_cvt_pk_bf16_f32 v23, v30, v31
    v_mfma_f32_32x32x16_bf16 v[64:79], v[208:211], v[16:19], v[64:79]
    ds_read_b128 v[128:131], v242 offset:7104
    v_exp_f32_e32 v32, v32
    v_exp_f32_e32 v33, v33
    v_exp_f32_e32 v34, v34
    v_exp_f32_e32 v35, v35
    v_cvt_pk_bf16_f32 v32, v32, v33
    v_mfma_f32_32x32x16_bf16 v[64:79], v[212:215], v[20:23], v[64:79]
    ds_read_b128 v[132:135], v242 offset:6720
    v_exp_f32_e32 v36, v36
    v_exp_f32_e32 v37, v37
    v_cvt_pk_bf16_f32 v33, v34, v35
    v_exp_f32_e32 v38, v38
    v_exp_f32_e32 v39, v39
    s_waitcnt lgkmcnt(2)
    v_mfma_f32_32x32x16_bf16 v[48:63], v[158:161], v[116:119], v[48:63]
    ds_read_b128 v[136:139], v242 offset:6336
    v_cvt_pk_bf16_f32 v34, v36, v37
    v_exp_f32_e32 v40, v40
    v_exp_f32_e32 v41, v41
    v_cvt_pk_bf16_f32 v35, v38, v39
    v_exp_f32_e32 v42, v42
    v_mfma_f32_32x32x8_bf16 v[48:63], v[162:163], v[120:121], v[48:63]
    ds_read_b128 v[140:143], v242 offset:5952
    v_exp_f32_e32 v43, v43
    v_cvt_pk_bf16_f32 v36, v40, v41
    v_exp_f32_e32 v44, v44
    v_exp_f32_e32 v45, v45
    v_cvt_pk_bf16_f32 v37, v42, v43
    v_exp_f32_e32 v46, v46
    v_exp_f32_e32 v47, v47
    v_cvt_pk_bf16_f32 v38, v44, v45
    v_rcp_f32_e32 v252, v72
    v_cvt_pk_bf16_f32 v39, v46, v47
    v_mul_f32_e32 v64, v64, v252
    v_mul_f32_e32 v65, v65, v252
    v_mul_f32_e32 v66, v66, v252
    v_mul_f32_e32 v67, v67, v252
    v_mul_f32_e32 v68, v68, v252
    v_mul_f32_e32 v69, v69, v252
    v_mul_f32_e32 v70, v70, v252
    v_mul_f32_e32 v71, v71, v252
    v_mul_f32_e32 v76, v76, v252
    v_mul_f32_e32 v77, v77, v252
    v_mul_f32_e32 v78, v78, v252
    v_mul_f32_e32 v79, v79, v252
    v_max3_f32 v250, v250, v72, v252
    v_cvt_pk_bf16_f32 v92, v64, v65
    v_cvt_pk_bf16_f32 v93, v66, v67
    v_cvt_pk_bf16_f32 v94, v68, v69
    v_cvt_pk_bf16_f32 v95, v70, v71
    v_cvt_pk_bf16_f32 v96, v76, v77
    v_cvt_pk_bf16_f32 v97, v78, v79
    v_mfma_f32_32x32x16_bf16 v[64:79], v[216:219], v[32:35], 0
    ds_read_b128 v[144:147], v241 offset:8640
    v_exp_f32_e32 v48, v48
    v_exp_f32_e32 v49, v49
    v_exp_f32_e32 v50, v50
    v_exp_f32_e32 v51, v51
    v_cvt_pk_bf16_f32 v48, v48, v49
    v_mfma_f32_32x32x16_bf16 v[64:79], v[220:223], v[36:39], v[64:79]
    ds_read_b128 v[148:151], v241 offset:8256
    v_exp_f32_e32 v52, v52
    v_exp_f32_e32 v53, v53
    v_cvt_pk_bf16_f32 v49, v50, v51
    v_exp_f32_e32 v54, v54
    v_exp_f32_e32 v55, v55
    s_waitcnt lgkmcnt(2)
    v_mfma_f32_32x32x16_bf16 v[128:143], v[164:167], v[98:101], v[128:143]
    ds_read_b128 v[152:155], v241 offset:7872
    v_cvt_pk_bf16_f32 v50, v52, v53
    v_exp_f32_e32 v56, v56
    v_exp_f32_e32 v57, v57
    v_cvt_pk_bf16_f32 v51, v54, v55
    v_exp_f32_e32 v58, v58
    v_mfma_f32_32x32x8_bf16 v[128:143], v[168:169], v[102:103], v[128:143]
    ds_read_b128 v[156:159], v241 offset:7488
    v_exp_f32_e32 v59, v59
    v_cvt_pk_bf16_f32 v52, v56, v57
    v_exp_f32_e32 v60, v60
    v_exp_f32_e32 v61, v61
    v_cvt_pk_bf16_f32 v53, v58, v59
    v_exp_f32_e32 v62, v62
    v_exp_f32_e32 v63, v63
    v_cvt_pk_bf16_f32 v54, v60, v61
    v_cvt_pk_bf16_f32 v55, v62, v63
    v_mfma_f32_32x32x16_bf16 v[64:79], v[208:211], v[48:51], v[64:79]
    s_nop 0
    v_exp_f32_e32 v128, v128
    v_exp_f32_e32 v129, v129
    v_exp_f32_e32 v130, v130
    v_exp_f32_e32 v131, v131
    v_mfma_f32_32x32x16_bf16 v[64:79], v[212:215], v[52:55], v[64:79]
    v_cvt_pk_bf16_f32 v128, v128, v129
    v_exp_f32_e32 v132, v132
    v_exp_f32_e32 v133, v133
    v_cvt_pk_bf16_f32 v129, v130, v131
    s_waitcnt lgkmcnt(0)
    v_mfma_f32_32x32x16_bf16 v[32:47], v[164:167], v[122:125], v[144:159]
    v_exp_f32_e32 v134, v134
    v_exp_f32_e32 v135, v135
    v_cvt_pk_bf16_f32 v130, v132, v133
    v_exp_f32_e32 v136, v136
    v_mfma_f32_32x32x16_bf16 v[144:159], v[170:173], v[98:101], v[144:159]
    v_exp_f32_e32 v137, v137
    v_cvt_pk_bf16_f32 v131, v134, v135
    v_exp_f32_e32 v138, v138
    v_exp_f32_e32 v139, v139
    v_mfma_f32_32x32x8_bf16 v[144:159], v[174:175], v[102:103], v[144:159]
    v_cvt_pk_bf16_f32 v132, v136, v137
    v_exp_f32_e32 v140, v140
    v_exp_f32_e32 v141, v141
    v_cvt_pk_bf16_f32 v133, v138, v139
    v_exp_f32_e32 v142, v142
    v_exp_f32_e32 v143, v143
    v_cvt_pk_bf16_f32 v134, v140, v141
    v_rcp_f32_e32 v252, v72
    v_cvt_pk_bf16_f32 v135, v142, v143
    v_mul_f32_e32 v64, v64, v252
    v_mul_f32_e32 v65, v65, v252
    v_mul_f32_e32 v66, v66, v252
    v_mul_f32_e32 v67, v67, v252
    v_mul_f32_e32 v68, v68, v252
    v_mul_f32_e32 v69, v69, v252
    v_mul_f32_e32 v70, v70, v252
    v_mul_f32_e32 v71, v71, v252
    v_mul_f32_e32 v76, v76, v252
    v_mul_f32_e32 v77, v77, v252
    v_mul_f32_e32 v78, v78, v252
    v_mul_f32_e32 v79, v79, v252
    v_max3_f32 v250, v250, v72, v252
    v_cvt_pk_bf16_f32 v116, v64, v65
    v_cvt_pk_bf16_f32 v117, v66, v67
    v_cvt_pk_bf16_f32 v118, v68, v69
    v_cvt_pk_bf16_f32 v119, v70, v71
    v_cvt_pk_bf16_f32 v120, v76, v77
    v_cvt_pk_bf16_f32 v121, v78, v79
    v_mfma_f32_32x32x16_bf16 v[64:79], v[232:235], v[128:131], 0
    ds_read_b128 v[48:51], v242 offset:10176
    ds_read_b128 v[52:55], v242 offset:9792
    v_exp_f32_e32 v144, v144
    v_exp_f32_e32 v145, v145
    v_exp_f32_e32 v146, v146
    v_exp_f32_e32 v147, v147
    v_cvt_pk_bf16_f32 v144, v144, v145
    v_exp_f32_e32 v148, v148
    v_mfma_f32_32x32x16_bf16 v[64:79], v[236:239], v[132:135], v[64:79]
    ds_read_b128 v[56:59], v242 offset:9408
    ds_read_b128 v[60:63], v242 offset:9024
    v_exp_f32_e32 v149, v149
    v_cvt_pk_bf16_f32 v145, v146, v147
    v_exp_f32_e32 v150, v150
    v_exp_f32_e32 v151, v151
    v_cvt_pk_bf16_f32 v146, v148, v149
    v_exp_f32_e32 v152, v152
    v_mfma_f32_32x32x8_bf16 v[32:47], v[168:169], v[126:127], v[32:47]
    v_exp_f32_e32 v153, v153
    v_cvt_pk_bf16_f32 v147, v150, v151
    v_exp_f32_e32 v154, v154
    v_exp_f32_e32 v155, v155
    v_cvt_pk_bf16_f32 v148, v152, v153
    v_exp_f32_e32 v156, v156
    v_exp_f32_e32 v157, v157
    v_cvt_pk_bf16_f32 v149, v154, v155
    v_exp_f32_e32 v158, v158
    v_exp_f32_e32 v159, v159
    v_cvt_pk_bf16_f32 v150, v156, v157
    v_cvt_pk_bf16_f32 v151, v158, v159
    v_mfma_f32_32x32x16_bf16 v[64:79], v[224:227], v[144:147], v[64:79]
    v_exp_f32_e32 v32, v32
    v_exp_f32_e32 v33, v33
    v_exp_f32_e32 v34, v34
    v_exp_f32_e32 v35, v35
    v_cvt_pk_bf16_f32 v32, v32, v33
    v_mfma_f32_32x32x16_bf16 v[64:79], v[228:231], v[148:151], v[64:79]
    v_exp_f32_e32 v36, v36
    v_exp_f32_e32 v37, v37
    v_cvt_pk_bf16_f32 v33, v34, v35
    v_exp_f32_e32 v38, v38
    v_exp_f32_e32 v39, v39
    s_waitcnt lgkmcnt(0)
    v_mfma_f32_32x32x16_bf16 v[48:63], v[170:173], v[122:125], v[48:63]
    v_cvt_pk_bf16_f32 v34, v36, v37
    v_exp_f32_e32 v40, v40
    v_exp_f32_e32 v41, v41
    v_cvt_pk_bf16_f32 v35, v38, v39
    v_exp_f32_e32 v42, v42
    v_mfma_f32_32x32x8_bf16 v[48:63], v[174:175], v[126:127], v[48:63]
    v_exp_f32_e32 v43, v43
    v_cvt_pk_bf16_f32 v36, v40, v41
    v_exp_f32_e32 v44, v44
    v_exp_f32_e32 v45, v45
    v_cvt_pk_bf16_f32 v37, v42, v43
    v_exp_f32_e32 v46, v46
    v_exp_f32_e32 v47, v47
    v_cvt_pk_bf16_f32 v38, v44, v45
    v_rcp_f32_e32 v252, v76
    v_cvt_pk_bf16_f32 v39, v46, v47
    v_mul_f32_e32 v64, v64, v252
    v_mul_f32_e32 v65, v65, v252
    v_mul_f32_e32 v66, v66, v252
    v_mul_f32_e32 v67, v67, v252
    v_mul_f32_e32 v68, v68, v252
    v_mul_f32_e32 v69, v69, v252
    v_mul_f32_e32 v70, v70, v252
    v_mul_f32_e32 v71, v71, v252
    v_mul_f32_e32 v72, v72, v252
    v_mul_f32_e32 v73, v73, v252
    v_mul_f32_e32 v74, v74, v252
    v_mul_f32_e32 v75, v75, v252
    v_max3_f32 v250, v250, v76, v252
    v_cvt_pk_bf16_f32 v98, v64, v65
    v_cvt_pk_bf16_f32 v99, v66, v67
    v_cvt_pk_bf16_f32 v100, v68, v69
    v_cvt_pk_bf16_f32 v101, v70, v71
    v_cvt_pk_bf16_f32 v102, v72, v73
    v_cvt_pk_bf16_f32 v103, v74, v75
    v_mfma_f32_32x32x16_bf16 v[64:79], v[232:235], v[32:35], 0
    v_exp_f32_e32 v48, v48
    v_exp_f32_e32 v49, v49
    v_exp_f32_e32 v50, v50
    v_exp_f32_e32 v51, v51
    v_cvt_pk_bf16_f32 v48, v48, v49
    v_exp_f32_e32 v52, v52
    v_mfma_f32_32x32x16_bf16 v[64:79], v[236:239], v[36:39], v[64:79]
    v_exp_f32_e32 v53, v53
    v_cvt_pk_bf16_f32 v49, v50, v51
    v_exp_f32_e32 v54, v54
    v_exp_f32_e32 v55, v55
    v_cvt_pk_bf16_f32 v50, v52, v53
    v_exp_f32_e32 v56, v56
    v_exp_f32_e32 v57, v57
    v_cvt_pk_bf16_f32 v51, v54, v55
    v_exp_f32_e32 v58, v58
    v_exp_f32_e32 v59, v59
    v_cvt_pk_bf16_f32 v52, v56, v57
    v_exp_f32_e32 v60, v60
    v_exp_f32_e32 v61, v61
    v_cvt_pk_bf16_f32 v53, v58, v59
    v_exp_f32_e32 v62, v62
    v_exp_f32_e32 v63, v63
    v_cvt_pk_bf16_f32 v54, v60, v61
    v_cvt_pk_bf16_f32 v55, v62, v63
    v_mfma_f32_32x32x16_bf16 v[64:79], v[224:227], v[48:51], v[64:79]
    s_nop 0
    v_mfma_f32_32x32x16_bf16 v[64:79], v[228:231], v[52:55], v[64:79]
    s_cmp_eq_u32 s39, 63
    s_cbranch_scc1 L_ool0
L_oolr0:
    buffer_load_dwordx4 v[0:3], v247, s[16:19], s48 offen offset:0 nt
    buffer_load_dwordx4 v[4:7], v248, s[16:19], s48 offen offset:0 nt
    buffer_load_dwordx4 v[8:11], v249, s[16:19], s48 offen offset:0 nt
    buffer_load_dwordx4 v[12:15], v247, s[16:19], s49 offen offset:0 nt
    buffer_load_dwordx4 v[16:19], v248, s[16:19], s49 offen offset:0 nt
    buffer_load_dwordx4 v[20:23], v249, s[16:19], s49 offen offset:0 nt
    buffer_load_dwordx4 v[24:27], v247, s[16:19], s50 offen offset:0 nt
    buffer_load_dwordx4 v[28:31], v248, s[16:19], s50 offen offset:0 nt
    buffer_load_dwordx4 v[32:35], v249, s[16:19], s50 offen offset:0 nt
    buffer_load_dwordx4 v[36:39], v247, s[16:19], s51 offen offset:0 nt
    buffer_load_dwordx4 v[40:43], v248, s[16:19], s51 offen offset:0 nt
    buffer_load_dwordx4 v[44:47], v249, s[16:19], s51 offen offset:0 nt
    s_cmp_eq_u32 s39, 63
    s_cbranch_scc1 L_ool1
L_oolr1:
    v_rcp_f32_e32 v252, v76
    s_nop 0
    v_mul_f32_e32 v64, v64, v252
    v_mul_f32_e32 v65, v65, v252
    v_mul_f32_e32 v66, v66, v252
    v_mul_f32_e32 v67, v67, v252
    v_mul_f32_e32 v68, v68, v252
    v_mul_f32_e32 v69, v69, v252
    v_mul_f32_e32 v70, v70, v252
    v_mul_f32_e32 v71, v71, v252
    v_mul_f32_e32 v72, v72, v252
    v_mul_f32_e32 v73, v73, v252
    v_mul_f32_e32 v74, v74, v252
    v_mul_f32_e32 v75, v75, v252
    v_max3_f32 v250, v250, v76, v252
    v_cvt_pk_bf16_f32 v122, v64, v65
    v_cvt_pk_bf16_f32 v123, v66, v67
    v_cvt_pk_bf16_f32 v124, v68, v69
    v_cvt_pk_bf16_f32 v125, v70, v71
    v_cvt_pk_bf16_f32 v126, v72, v73
    v_cvt_pk_bf16_f32 v127, v74, v75
    v_cmp_ngt_f32 vcc, 0x4e800000, v250
    s_setprio 1
    v_add_u32 v254, 55296, v240
    ds_read_b128 v[160:163], v254 offset:0
    ds_read_b128 v[164:167], v254 offset:3072
    ds_read_b128 v[168:171], v254 offset:6144
    s_waitcnt lgkmcnt(2)
    v_mfma_f32_32x32x16_bf16 v[128:143], v[160:163], v[80:83], 0
    ds_read_b128 v[172:175], v254 offset:9216
    s_cmp_lg_u64 vcc, 0
    s_cselect_b32 s74, 1, 0
    s_or_b32 s63, s63, s74
    s_waitcnt lgkmcnt(2)
    v_mfma_f32_32x32x16_bf16 v[128:143], v[164:167], v[84:87], v[128:143]
    ds_read_b128 v[64:67], v254 offset:12288
    s_waitcnt lgkmcnt(2)
    v_mfma_f32_32x32x16_bf16 v[128:143], v[168:171], v[88:91], v[128:143]
    ds_read_b128 v[68:71], v254 offset:15360
    s_waitcnt lgkmcnt(2)
    v_mfma_f32_32x32x16_bf16 v[128:143], v[172:175], v[92:95], v[128:143]
    ds_read_b128 v[72:75], v254 offset:1024
    s_waitcnt lgkmcnt(2)
    v_mfma_f32_32x32x16_bf16 v[128:143], v[64:67], v[96:99], v[128:143]
    ds_read_b128 v[76:79], v254 offset:4096
    s_waitcnt lgkmcnt(2)
    v_mfma_f32_32x32x16_bf16 v[128:143], v[68:71], v[100:103], v[128:143]
    ds_read_b128 v[160:163], v254 offset:7168
    s_waitcnt lgkmcnt(2)
    v_mfma_f32_32x32x16_bf16 v[144:159], v[72:75], v[80:83], 0
    ds_read_b128 v[164:167], v254 offset:10240
    s_waitcnt lgkmcnt(2)
    v_mfma_f32_32x32x16_bf16 v[144:159], v[76:79], v[84:87], v[144:159]
    ds_read_b128 v[168:171], v254 offset:13312
    s_waitcnt lgkmcnt(2)
    v_mfma_f32_32x32x16_bf16 v[144:159], v[160:163], v[88:91], v[144:159]
    ds_read_b128 v[172:175], v254 offset:16384
    s_setprio 3
    s_nop 0
    v_cvt_pk_bf16_f32 v128, v128, v129
    v_cvt_pk_bf16_f32 v129, v130, v131
    v_cvt_pk_bf16_f32 v130, v132, v133
    v_cvt_pk_bf16_f32 v131, v134, v135
    s_setprio 1
    s_waitcnt lgkmcnt(2)
    v_mfma_f32_32x32x16_bf16 v[144:159], v[164:167], v[92:95], v[144:159]
    ds_read_b128 v[64:67], v254 offset:2048
    ds_write_b128 v243, v[128:131] offset:0
    s_setprio 3
    v_cvt_pk_bf16_f32 v132, v136, v137
    v_cvt_pk_bf16_f32 v133, v138, v139
    v_cvt_pk_bf16_f32 v134, v140, v141
    v_cvt_pk_bf16_f32 v135, v142, v143
    s_setprio 1
    s_waitcnt lgkmcnt(3)
    v_mfma_f32_32x32x16_bf16 v[144:159], v[168:171], v[96:99], v[144:159]
    ds_read_b128 v[68:71], v254 offset:5120
    ds_write_b128 v243, v[132:135] offset:32
    s_waitcnt lgkmcnt(4)
    v_mfma_f32_32x32x16_bf16 v[144:159], v[172:175], v[100:103], v[144:159]
    ds_read_b128 v[72:75], v254 offset:8192
    s_waitcnt lgkmcnt(4)
    v_mfma_f32_32x32x16_bf16 v[48:63], v[64:67], v[80:83], 0
    ds_read_b128 v[76:79], v254 offset:11264
    s_waitcnt lgkmcnt(3)
    v_mfma_f32_32x32x16_bf16 v[48:63], v[68:71], v[84:87], v[48:63]
    ds_read_b128 v[160:163], v254 offset:14336
    s_waitcnt lgkmcnt(2)
    v_mfma_f32_32x32x16_bf16 v[48:63], v[72:75], v[88:91], v[48:63]
    ds_read_b128 v[164:167], v254 offset:17408
    s_setprio 3
    s_nop 0
    v_cvt_pk_bf16_f32 v144, v144, v145
    v_cvt_pk_bf16_f32 v145, v146, v147
    v_cvt_pk_bf16_f32 v146, v148, v149
    v_cvt_pk_bf16_f32 v147, v150, v151
    s_setprio 1
    s_waitcnt lgkmcnt(2)
    v_mfma_f32_32x32x16_bf16 v[48:63], v[76:79], v[92:95], v[48:63]
    ds_read_b128 v[168:171], v254 offset:0
    ds_write_b128 v243, v[144:147] offset:64
    s_setprio 3
    v_cvt_pk_bf16_f32 v148, v152, v153
    v_cvt_pk_bf16_f32 v149, v154, v155
    v_cvt_pk_bf16_f32 v150, v156, v157
    v_cvt_pk_bf16_f32 v151, v158, v159
    s_setprio 1
    s_waitcnt lgkmcnt(3)
    v_mfma_f32_32x32x16_bf16 v[48:63], v[160:163], v[96:99], v[48:63]
    ds_read_b128 v[172:175], v254 offset:3072
    ds_write_b128 v243, v[148:151] offset:96
    s_waitcnt lgkmcnt(4)
    v_mfma_f32_32x32x16_bf16 v[48:63], v[164:167], v[100:103], v[48:63]
    ds_read_b128 v[64:67], v254 offset:6144
    s_waitcnt lgkmcnt(4)
    v_mfma_f32_32x32x16_bf16 v[128:143], v[168:171], v[104:107], 0
    ds_read_b128 v[68:71], v254 offset:9216
    s_waitcnt lgkmcnt(3)
    v_mfma_f32_32x32x16_bf16 v[128:143], v[172:175], v[108:111], v[128:143]
    ds_read_b128 v[72:75], v254 offset:12288
    s_waitcnt lgkmcnt(2)
    v_mfma_f32_32x32x16_bf16 v[128:143], v[64:67], v[112:115], v[128:143]
    ds_read_b128 v[76:79], v254 offset:15360
    s_setprio 3
    s_nop 0
    v_cvt_pk_bf16_f32 v48, v48, v49
    v_cvt_pk_bf16_f32 v49, v50, v51
    v_cvt_pk_bf16_f32 v50, v52, v53
    v_cvt_pk_bf16_f32 v51, v54, v55
    s_setprio 1
    s_waitcnt lgkmcnt(2)
    v_mfma_f32_32x32x16_bf16 v[128:143], v[68:71], v[116:119], v[128:143]
    ds_read_b128 v[160:163], v254 offset:1024
    ds_write_b128 v245, v[48:51] offset:0
    s_setprio 3
    v_cvt_pk_bf16_f32 v52, v56, v57
    v_cvt_pk_bf16_f32 v53, v58, v59
    v_cvt_pk_bf16_f32 v54, v60, v61
    v_cvt_pk_bf16_f32 v55, v62, v63
    s_setprio 1
    s_waitcnt lgkmcnt(3)
    v_mfma_f32_32x32x16_bf16 v[128:143], v[72:75], v[120:123], v[128:143]
    ds_read_b128 v[164:167], v254 offset:4096
    ds_write_b128 v246, v[52:55] offset:0
    ds_read_b128 v[80:83], v244 offset:0
    ds_read_b128 v[84:87], v244 offset:1024
    ds_read_b128 v[88:91], v244 offset:2048
    s_waitcnt lgkmcnt(7)
    v_mfma_f32_32x32x16_bf16 v[128:143], v[76:79], v[124:127], v[128:143]
    ds_read_b128 v[168:171], v254 offset:7168
    ds_read_b128 v[92:95], v244 offset:3072
    ds_read_b128 v[96:99], v244 offset:4096
    ds_read_b128 v[100:103], v244 offset:5120
    s_waitcnt vmcnt(11)
    ds_write_b128 v244, v[0:3] offset:0
    s_waitcnt lgkmcnt(11)
    v_mfma_f32_32x32x16_bf16 v[144:159], v[160:163], v[104:107], 0
    ds_read_b128 v[172:175], v254 offset:10240
    s_waitcnt vmcnt(10)
    ds_write_b128 v244, v[4:7] offset:1024
    s_waitcnt vmcnt(9)
    ds_write_b128 v244, v[8:11] offset:2048
    s_waitcnt vmcnt(8)
    ds_write_b128 v244, v[12:15] offset:3072
    s_waitcnt vmcnt(7)
    s_waitcnt lgkmcnt(13)
    ds_write_b128 v244, v[16:19] offset:4096
    v_mfma_f32_32x32x16_bf16 v[144:159], v[164:167], v[108:111], v[144:159]
    ds_read_b128 v[64:67], v254 offset:13312
    s_waitcnt vmcnt(6)
    s_waitcnt lgkmcnt(13)
    ds_write_b128 v244, v[20:23] offset:5120
    ds_read_b128 v[0:3], v243 offset:0
    s_waitcnt lgkmcnt(13)
    ds_read_b128 v[4:7], v243 offset:32
    ds_read_b128 v[8:11], v243 offset:64
    s_waitcnt lgkmcnt(14)
    v_mfma_f32_32x32x16_bf16 v[144:159], v[168:171], v[112:115], v[144:159]
    ds_read_b128 v[68:71], v254 offset:16384
    s_waitcnt lgkmcnt(13)
    ds_read_b128 v[12:15], v243 offset:96
    ds_read_b128 v[16:19], v245 offset:0
    s_waitcnt lgkmcnt(13)
    ds_read_b128 v[20:23], v246 offset:0
    s_waitcnt vmcnt(5)
    ds_write_b128 v244, v[24:27] offset:0
    s_waitcnt lgkmcnt(14)
    v_mfma_f32_32x32x16_bf16 v[144:159], v[172:175], v[116:119], v[144:159]
    ds_read_b128 v[72:75], v254 offset:2048
    s_waitcnt vmcnt(4)
    s_waitcnt lgkmcnt(13)
    ds_write_b128 v244, v[28:31] offset:1024
    s_waitcnt vmcnt(3)
    ds_write_b128 v244, v[32:35] offset:2048
    s_waitcnt vmcnt(2)
    s_waitcnt lgkmcnt(13)
    ds_write_b128 v244, v[36:39] offset:3072
    s_waitcnt vmcnt(1)
    ds_write_b128 v244, v[40:43] offset:4096
    s_waitcnt lgkmcnt(14)
    v_mfma_f32_32x32x16_bf16 v[144:159], v[64:67], v[120:123], v[144:159]
    ds_read_b128 v[76:79], v254 offset:5120
    s_waitcnt vmcnt(0)
    s_waitcnt lgkmcnt(13)
    ds_write_b128 v244, v[44:47] offset:5120
    ds_read_b128 v[24:27], v243 offset:0
    s_waitcnt lgkmcnt(13)
    ds_read_b128 v[28:31], v243 offset:32
    ds_read_b128 v[32:35], v243 offset:64
    s_waitcnt lgkmcnt(14)
    v_mfma_f32_32x32x16_bf16 v[144:159], v[68:71], v[124:127], v[144:159]
    ds_read_b128 v[160:163], v254 offset:8192
    s_waitcnt lgkmcnt(13)
    ds_read_b128 v[36:39], v243 offset:96
    ds_read_b128 v[40:43], v245 offset:0
    s_waitcnt lgkmcnt(13)
    ds_read_b128 v[44:47], v246 offset:0
    s_waitcnt lgkmcnt(13)
    v_mfma_f32_32x32x16_bf16 v[48:63], v[72:75], v[104:107], 0
    ds_read_b128 v[164:167], v254 offset:11264
    buffer_store_dwordx4 v[96:99], v248, s[20:23], s45 offen offset:0 sc0 sc1 nt
    s_setprio 3
    v_cvt_pk_bf16_f32 v128, v128, v129
    v_cvt_pk_bf16_f32 v129, v130, v131
    v_cvt_pk_bf16_f32 v130, v132, v133
    v_cvt_pk_bf16_f32 v131, v134, v135
    s_setprio 1
    s_waitcnt lgkmcnt(9)
    v_mfma_f32_32x32x16_bf16 v[48:63], v[76:79], v[108:111], v[48:63]
    ds_read_b128 v[168:171], v254 offset:14336
    buffer_store_dwordx4 v[100:103], v249, s[20:23], s45 offen offset:0 sc0 sc1 nt
    ds_write_b128 v243, v[128:131] offset:0
    s_setprio 3
    v_cvt_pk_bf16_f32 v132, v136, v137
    v_cvt_pk_bf16_f32 v133, v138, v139
    v_cvt_pk_bf16_f32 v134, v140, v141
    v_cvt_pk_bf16_f32 v135, v142, v143
    s_setprio 1
    s_waitcnt lgkmcnt(6)
    v_mfma_f32_32x32x16_bf16 v[48:63], v[160:163], v[112:115], v[48:63]
    ds_read_b128 v[172:175], v254 offset:17408
    buffer_store_dwordx4 v[80:83], v247, s[20:23], s44 offen offset:0 sc0 sc1 nt
    ds_write_b128 v243, v[132:135] offset:32
    s_setprio 3
    v_cvt_pk_bf16_f32 v144, v144, v145
    v_cvt_pk_bf16_f32 v145, v146, v147
    v_cvt_pk_bf16_f32 v146, v148, v149
    v_cvt_pk_bf16_f32 v147, v150, v151
    s_setprio 1
    s_waitcnt lgkmcnt(4)
    v_mfma_f32_32x32x16_bf16 v[48:63], v[164:167], v[116:119], v[48:63]
    buffer_store_dwordx4 v[84:87], v248, s[20:23], s44 offen offset:0 sc0 sc1 nt
    ds_read_b128 v[96:99], v240 offset:6144
    ds_write_b128 v243, v[144:147] offset:64
    s_setprio 3
    v_cvt_pk_bf16_f32 v148, v152, v153
    v_cvt_pk_bf16_f32 v149, v154, v155
    v_cvt_pk_bf16_f32 v150, v156, v157
    v_cvt_pk_bf16_f32 v151, v158, v159
    s_setprio 1
    s_waitcnt lgkmcnt(5)
    v_mfma_f32_32x32x16_bf16 v[48:63], v[168:171], v[120:123], v[48:63]
    buffer_store_dwordx4 v[88:91], v249, s[20:23], s44 offen offset:0 sc0 sc1 nt
    ds_read_b128 v[100:103], v240 offset:15360
    ds_write_b128 v243, v[148:151] offset:96
    s_waitcnt lgkmcnt(5)
    v_mfma_f32_32x32x16_bf16 v[48:63], v[172:175], v[124:127], v[48:63]
    buffer_store_dwordx4 v[92:95], v247, s[20:23], s45 offen offset:0 sc0 sc1 nt
    ds_read_b128 v[120:123], v240 offset:24576
    s_setprio 0
    s_cmp_eq_u32 s39, 63
    s_cbranch_scc1 L_ool2
L_oolr2:
    s_waitcnt lgkmcnt(4)
    v_mfma_f32_32x32x16_bf16 v[80:95], v[0:3], v[96:99], 0
    ds_read_b128 v[124:127], v240 offset:33792
    s_setprio 3
    s_nop 2
    v_cvt_pk_bf16_f32 v48, v48, v49
    v_cvt_pk_bf16_f32 v49, v50, v51
    v_cvt_pk_bf16_f32 v50, v52, v53
    v_cvt_pk_bf16_f32 v51, v54, v55
    s_setprio 0
    v_mfma_f32_32x32x16_bf16 v[104:119], v[24:27], v[96:99], 0
    ds_write_b128 v245, v[48:51] offset:0
    s_setprio 3
    v_cvt_pk_bf16_f32 v52, v56, v57
    v_cvt_pk_bf16_f32 v53, v58, v59
    v_cvt_pk_bf16_f32 v54, v60, v61
    v_cvt_pk_bf16_f32 v55, v62, v63
    s_setprio 0
    s_waitcnt lgkmcnt(4)
    v_mfma_f32_32x32x16_bf16 v[80:95], v[4:7], v[100:103], v[80:95]
    ds_read_b128 v[96:99], v240 offset:43008
    ds_write_b128 v246, v[52:55] offset:0
    ds_read_b128 v[128:131], v244 offset:0
    v_mfma_f32_32x32x16_bf16 v[104:119], v[28:31], v[100:103], v[104:119]
    ds_read_b128 v[132:135], v244 offset:1024
    ds_read_b128 v[136:139], v244 offset:2048
    s_waitcnt lgkmcnt(7)
    v_mfma_f32_32x32x16_bf16 v[80:95], v[8:11], v[120:123], v[80:95]
    ds_read_b128 v[100:103], v240 offset:52224
    ds_read_b128 v[140:143], v244 offset:3072
    ds_read_b128 v[160:163], v244 offset:4096
    v_mfma_f32_32x32x16_bf16 v[104:119], v[32:35], v[120:123], v[104:119]
    ds_read_b128 v[164:167], v244 offset:5120
    s_waitcnt lgkmcnt(10)
    v_mfma_f32_32x32x16_bf16 v[80:95], v[12:15], v[124:127], v[80:95]
    ds_read_b128 v[120:123], v240 offset:7168
    s_waitcnt lgkmcnt(7)
    buffer_store_dwordx4 v[128:131], v247, s[20:23], s46 offen offset:0 sc0 sc1 nt
    v_mfma_f32_32x32x16_bf16 v[104:119], v[36:39], v[124:127], v[104:119]
    v_mfma_f32_32x32x16_bf16 v[80:95], v[16:19], v[96:99], v[80:95]
    ds_read_b128 v[124:127], v240 offset:16384
    v_mfma_f32_32x32x16_bf16 v[104:119], v[40:43], v[96:99], v[104:119]
    s_waitcnt lgkmcnt(7)
    buffer_store_dwordx4 v[132:135], v248, s[20:23], s46 offen offset:0 sc0 sc1 nt
    s_waitcnt lgkmcnt(5)
    v_mfma_f32_32x32x16_bf16 v[80:95], v[20:23], v[100:103], v[80:95]
    ds_read_b128 v[96:99], v240 offset:25600
    v_mfma_f32_32x32x16_bf16 v[104:119], v[44:47], v[100:103], v[104:119]
    s_waitcnt lgkmcnt(2)
    v_mfma_f32_32x32x16_bf16 v[48:63], v[0:3], v[120:123], 0
    ds_read_b128 v[100:103], v240 offset:34816
    buffer_store_dwordx4 v[136:139], v249, s[20:23], s46 offen offset:0 sc0 sc1 nt
    v_mfma_f32_32x32x16_bf16 v[64:79], v[24:27], v[120:123], 0
    s_waitcnt lgkmcnt(2)
    v_mfma_f32_32x32x16_bf16 v[48:63], v[4:7], v[124:127], v[48:63]
    ds_read_b128 v[120:123], v240 offset:44032
    s_setprio 3
    s_mov_b64 exec, s[52:53]
    v_cvt_pk_bf16_f32 v224, v80, v81
    v_cvt_pk_bf16_f32 v225, v82, v83
    s_not_b64 exec, exec
    v_cvt_pk_bf16_f32 v176, v80, v81
    v_cvt_pk_bf16_f32 v177, v82, v83
    s_mov_b64 exec, -1
    s_setprio 0
    v_mfma_f32_32x32x16_bf16 v[64:79], v[28:31], v[124:127], v[64:79]
    buffer_store_dwordx4 v[140:143], v247, s[20:23], s47 offen offset:0 sc0 sc1 nt
    s_setprio 3
    s_mov_b64 exec, s[52:53]
    v_cvt_pk_bf16_f32 v226, v84, v85
    v_cvt_pk_bf16_f32 v227, v86, v87
    s_not_b64 exec, exec
    v_cvt_pk_bf16_f32 v178, v84, v85
    v_cvt_pk_bf16_f32 v179, v86, v87
    s_mov_b64 exec, -1
    s_setprio 0
    s_waitcnt lgkmcnt(2)
    v_mfma_f32_32x32x16_bf16 v[48:63], v[8:11], v[96:99], v[48:63]
    ds_read_b128 v[124:127], v240 offset:53248
    s_setprio 3
    s_mov_b64 exec, s[52:53]
    v_cvt_pk_bf16_f32 v228, v88, v89
    v_cvt_pk_bf16_f32 v229, v90, v91
    s_not_b64 exec, exec
    v_cvt_pk_bf16_f32 v180, v88, v89
    v_cvt_pk_bf16_f32 v181, v90, v91
    s_mov_b64 exec, -1
    s_setprio 0
    v_mfma_f32_32x32x16_bf16 v[64:79], v[32:35], v[96:99], v[64:79]
    s_setprio 3
    s_mov_b64 exec, s[52:53]
    v_cvt_pk_bf16_f32 v230, v92, v93
    v_cvt_pk_bf16_f32 v231, v94, v95
    s_not_b64 exec, exec
    v_cvt_pk_bf16_f32 v182, v92, v93
    v_cvt_pk_bf16_f32 v183, v94, v95
    s_mov_b64 exec, -1
    s_setprio 0
    s_waitcnt lgkmcnt(2)
    v_mfma_f32_32x32x16_bf16 v[48:63], v[12:15], v[100:103], v[48:63]
    ds_read_b128 v[96:99], v240 offset:8192
    buffer_store_dwordx4 v[160:163], v248, s[20:23], s47 offen offset:0 sc0 sc1 nt
    s_setprio 3
    s_mov_b64 exec, s[52:53]
    v_cvt_pk_bf16_f32 v232, v104, v105
    v_cvt_pk_bf16_f32 v233, v106, v107
    s_not_b64 exec, exec
    v_cvt_pk_bf16_f32 v184, v104, v105
    v_cvt_pk_bf16_f32 v185, v106, v107
    s_mov_b64 exec, -1
    s_setprio 0
    v_mfma_f32_32x32x16_bf16 v[64:79], v[36:39], v[100:103], v[64:79]
    s_setprio 3
    s_mov_b64 exec, s[52:53]
    v_cvt_pk_bf16_f32 v234, v108, v109
    v_cvt_pk_bf16_f32 v235, v110, v111
    s_not_b64 exec, exec
    v_cvt_pk_bf16_f32 v186, v108, v109
    v_cvt_pk_bf16_f32 v187, v110, v111
    s_mov_b64 exec, -1
    s_setprio 0
    s_waitcnt lgkmcnt(2)
    v_mfma_f32_32x32x16_bf16 v[48:63], v[16:19], v[120:123], v[48:63]
    ds_read_b128 v[100:103], v240 offset:17408
    s_setprio 3
    s_mov_b64 exec, s[52:53]
    v_cvt_pk_bf16_f32 v236, v112, v113
    v_cvt_pk_bf16_f32 v237, v114, v115
    s_not_b64 exec, exec
    v_cvt_pk_bf16_f32 v188, v112, v113
    v_cvt_pk_bf16_f32 v189, v114, v115
    s_mov_b64 exec, -1
    s_setprio 0
    v_mfma_f32_32x32x16_bf16 v[64:79], v[40:43], v[120:123], v[64:79]
    buffer_store_dwordx4 v[164:167], v249, s[20:23], s47 offen offset:0 sc0 sc1 nt
    s_setprio 3
    s_mov_b64 exec, s[52:53]
    v_cvt_pk_bf16_f32 v238, v116, v117
    v_cvt_pk_bf16_f32 v239, v118, v119
    s_not_b64 exec, exec
    v_cvt_pk_bf16_f32 v190, v116, v117
    v_cvt_pk_bf16_f32 v191, v118, v119
    s_mov_b64 exec, -1
    s_setprio 0
    s_waitcnt lgkmcnt(2)
    v_mfma_f32_32x32x16_bf16 v[48:63], v[20:23], v[124:127], v[48:63]
    ds_read_b128 v[120:123], v240 offset:26624
    v_mfma_f32_32x32x16_bf16 v[64:79], v[44:47], v[124:127], v[64:79]
    s_waitcnt lgkmcnt(2)
    v_mfma_f32_32x32x16_bf16 v[80:95], v[0:3], v[96:99], 0
    ds_read_b128 v[124:127], v240 offset:35840
    v_mfma_f32_32x32x16_bf16 v[104:119], v[24:27], v[96:99], 0
    s_waitcnt lgkmcnt(2)
    v_mfma_f32_32x32x16_bf16 v[80:95], v[4:7], v[100:103], v[80:95]
    ds_read_b128 v[96:99], v240 offset:45056
    s_setprio 3
    s_mov_b64 exec, s[54:55]
    s_nop 0
    v_cvt_pk_bf16_f32 v224, v48, v49
    v_cvt_pk_bf16_f32 v225, v50, v51
    s_not_b64 exec, exec
    v_cvt_pk_bf16_f32 v192, v48, v49
    v_cvt_pk_bf16_f32 v193, v50, v51
    s_mov_b64 exec, -1
    s_setprio 0
    v_mfma_f32_32x32x16_bf16 v[104:119], v[28:31], v[100:103], v[104:119]
    s_setprio 3
    s_mov_b64 exec, s[54:55]
    v_cvt_pk_bf16_f32 v226, v52, v53
    v_cvt_pk_bf16_f32 v227, v54, v55
    s_not_b64 exec, exec
    v_cvt_pk_bf16_f32 v194, v52, v53
    v_cvt_pk_bf16_f32 v195, v54, v55
    s_mov_b64 exec, -1
    s_setprio 0
    s_waitcnt lgkmcnt(2)
    v_mfma_f32_32x32x16_bf16 v[80:95], v[8:11], v[120:123], v[80:95]
    ds_read_b128 v[100:103], v240 offset:54272
    s_setprio 3
    s_mov_b64 exec, s[54:55]
    v_cvt_pk_bf16_f32 v228, v56, v57
    v_cvt_pk_bf16_f32 v229, v58, v59
    s_not_b64 exec, exec
    v_cvt_pk_bf16_f32 v196, v56, v57
    v_cvt_pk_bf16_f32 v197, v58, v59
    s_mov_b64 exec, -1
    s_setprio 0
    v_mfma_f32_32x32x16_bf16 v[104:119], v[32:35], v[120:123], v[104:119]
    s_setprio 3
    s_mov_b64 exec, s[54:55]
    v_cvt_pk_bf16_f32 v230, v60, v61
    v_cvt_pk_bf16_f32 v231, v62, v63
    s_not_b64 exec, exec
    v_cvt_pk_bf16_f32 v198, v60, v61
    v_cvt_pk_bf16_f32 v199, v62, v63
    s_mov_b64 exec, -1
    s_setprio 0
    s_waitcnt lgkmcnt(2)
    v_mfma_f32_32x32x16_bf16 v[80:95], v[12:15], v[124:127], v[80:95]
    ds_read_b128 v[120:123], v240 offset:3072
    s_setprio 3
    s_mov_b64 exec, s[54:55]
    v_cvt_pk_bf16_f32 v232, v64, v65
    v_cvt_pk_bf16_f32 v233, v66, v67
    s_not_b64 exec, exec
    v_cvt_pk_bf16_f32 v200, v64, v65
    v_cvt_pk_bf16_f32 v201, v66, v67
    s_mov_b64 exec, -1
    s_setprio 0
    v_mfma_f32_32x32x16_bf16 v[104:119], v[36:39], v[124:127], v[104:119]
    s_setprio 3
    s_mov_b64 exec, s[54:55]
    v_cvt_pk_bf16_f32 v234, v68, v69
    v_cvt_pk_bf16_f32 v235, v70, v71
    s_not_b64 exec, exec
    v_cvt_pk_bf16_f32 v202, v68, v69
    v_cvt_pk_bf16_f32 v203, v70, v71
    s_mov_b64 exec, -1
    s_setprio 0
    s_waitcnt lgkmcnt(2)
    v_mfma_f32_32x32x16_bf16 v[80:95], v[16:19], v[96:99], v[80:95]
    ds_read_b128 v[124:127], v240 offset:12288
    s_setprio 3
    s_mov_b64 exec, s[54:55]
    v_cvt_pk_bf16_f32 v236, v72, v73
    v_cvt_pk_bf16_f32 v237, v74, v75
    s_not_b64 exec, exec
    v_cvt_pk_bf16_f32 v204, v72, v73
    v_cvt_pk_bf16_f32 v205, v74, v75
    s_mov_b64 exec, -1
    s_setprio 0
    v_mfma_f32_32x32x16_bf16 v[104:119], v[40:43], v[96:99], v[104:119]
    s_setprio 3
    s_mov_b64 exec, s[54:55]
    v_cvt_pk_bf16_f32 v238, v76, v77
    v_cvt_pk_bf16_f32 v239, v78, v79
    s_not_b64 exec, exec
    v_cvt_pk_bf16_f32 v206, v76, v77
    v_cvt_pk_bf16_f32 v207, v78, v79
    s_mov_b64 exec, -1
    s_setprio 0
    s_waitcnt lgkmcnt(2)
    v_mfma_f32_32x32x16_bf16 v[80:95], v[20:23], v[100:103], v[80:95]
    ds_read_b128 v[96:99], v240 offset:21504
    v_mfma_f32_32x32x16_bf16 v[104:119], v[44:47], v[100:103], v[104:119]
    s_setprio 1
    s_waitcnt lgkmcnt(2)
    v_mfma_f32_32x32x16_bf16 v[48:63], v[120:123], v[0:3], 0
    ds_read_b128 v[100:103], v240 offset:30720
    v_mfma_f32_32x32x16_bf16 v[64:79], v[120:123], v[24:27], 0
    s_waitcnt lgkmcnt(2)
    v_mfma_f32_32x32x16_bf16 v[48:63], v[124:127], v[4:7], v[48:63]
    ds_read_b128 v[120:123], v240 offset:39936
    s_setprio 3
    s_mov_b64 exec, s[56:57]
    v_cvt_pk_bf16_f32 v224, v80, v81
    v_cvt_pk_bf16_f32 v225, v82, v83
    s_not_b64 exec, exec
    v_cvt_pk_bf16_f32 v208, v80, v81
    v_cvt_pk_bf16_f32 v209, v82, v83
    s_mov_b64 exec, -1
    s_setprio 1
    v_mfma_f32_32x32x16_bf16 v[64:79], v[124:127], v[28:31], v[64:79]
    s_setprio 3
    s_mov_b64 exec, s[56:57]
    v_cvt_pk_bf16_f32 v226, v84, v85
    v_cvt_pk_bf16_f32 v227, v86, v87
    s_not_b64 exec, exec
    v_cvt_pk_bf16_f32 v210, v84, v85
    v_cvt_pk_bf16_f32 v211, v86, v87
    s_mov_b64 exec, -1
    s_setprio 1
    s_waitcnt lgkmcnt(2)
    v_mfma_f32_32x32x16_bf16 v[48:63], v[96:99], v[8:11], v[48:63]
    ds_read_b128 v[124:127], v240 offset:49152
    s_setprio 3
    s_mov_b64 exec, s[56:57]
    v_cvt_pk_bf16_f32 v228, v88, v89
    v_cvt_pk_bf16_f32 v229, v90, v91
    s_not_b64 exec, exec
    v_cvt_pk_bf16_f32 v212, v88, v89
    v_cvt_pk_bf16_f32 v213, v90, v91
    s_mov_b64 exec, -1
    s_setprio 1
    v_mfma_f32_32x32x16_bf16 v[64:79], v[96:99], v[32:35], v[64:79]
    s_setprio 3
    s_mov_b64 exec, s[56:57]
    v_cvt_pk_bf16_f32 v230, v92, v93
    v_cvt_pk_bf16_f32 v231, v94, v95
    s_not_b64 exec, exec
    v_cvt_pk_bf16_f32 v214, v92, v93
    v_cvt_pk_bf16_f32 v215, v94, v95
    s_mov_b64 exec, -1
    s_setprio 1
    s_waitcnt lgkmcnt(2)
    v_mfma_f32_32x32x16_bf16 v[48:63], v[100:103], v[12:15], v[48:63]
    ds_read_b128 v[96:99], v240 offset:4096
    s_setprio 3
    s_mov_b64 exec, s[56:57]
    v_cvt_pk_bf16_f32 v232, v104, v105
    v_cvt_pk_bf16_f32 v233, v106, v107
    s_not_b64 exec, exec
    v_cvt_pk_bf16_f32 v216, v104, v105
    v_cvt_pk_bf16_f32 v217, v106, v107
    s_mov_b64 exec, -1
    s_setprio 1
    v_mfma_f32_32x32x16_bf16 v[64:79], v[100:103], v[36:39], v[64:79]
    s_setprio 3
    s_mov_b64 exec, s[56:57]
    v_cvt_pk_bf16_f32 v234, v108, v109
    v_cvt_pk_bf16_f32 v235, v110, v111
    s_not_b64 exec, exec
    v_cvt_pk_bf16_f32 v218, v108, v109
    v_cvt_pk_bf16_f32 v219, v110, v111
    s_mov_b64 exec, -1
    s_setprio 1
    s_waitcnt lgkmcnt(2)
    v_mfma_f32_32x32x16_bf16 v[48:63], v[120:123], v[16:19], v[48:63]
    ds_read_b128 v[100:103], v240 offset:13312
    s_setprio 3
    s_mov_b64 exec, s[56:57]
    v_cvt_pk_bf16_f32 v236, v112, v113
    v_cvt_pk_bf16_f32 v237, v114, v115
    s_not_b64 exec, exec
    v_cvt_pk_bf16_f32 v220, v112, v113
    v_cvt_pk_bf16_f32 v221, v114, v115
    s_mov_b64 exec, -1
    s_setprio 1
    v_mfma_f32_32x32x16_bf16 v[64:79], v[120:123], v[40:43], v[64:79]
    s_setprio 3
    s_mov_b64 exec, s[56:57]
    v_cvt_pk_bf16_f32 v238, v116, v117
    v_cvt_pk_bf16_f32 v239, v118, v119
    s_not_b64 exec, exec
    v_cvt_pk_bf16_f32 v222, v116, v117
    v_cvt_pk_bf16_f32 v223, v118, v119
    s_mov_b64 exec, -1
    s_setprio 1
    s_waitcnt lgkmcnt(2)
    v_mfma_f32_32x32x16_bf16 v[48:63], v[124:127], v[20:23], v[48:63]
    ds_read_b128 v[120:123], v240 offset:22528
    v_mfma_f32_32x32x16_bf16 v[64:79], v[124:127], v[44:47], v[64:79]
    s_waitcnt lgkmcnt(2)
    v_mfma_f32_32x32x16_bf16 v[80:95], v[96:99], v[0:3], 0
    ds_read_b128 v[124:127], v240 offset:31744
    v_mfma_f32_32x32x16_bf16 v[104:119], v[96:99], v[24:27], 0
    s_waitcnt lgkmcnt(2)
    v_mfma_f32_32x32x16_bf16 v[80:95], v[100:103], v[4:7], v[80:95]
    ds_read_b128 v[96:99], v240 offset:40960
    v_mfma_f32_32x32x16_bf16 v[104:119], v[100:103], v[28:31], v[104:119]
    s_setprio 3
    s_nop 0
    v_cvt_pk_bf16_f32 v134, v48, v49
    v_cvt_pk_bf16_f32 v135, v50, v51
    v_cvt_pk_bf16_f32 v136, v52, v53
    v_cvt_pk_bf16_f32 v137, v54, v55
    s_setprio 1
    s_waitcnt lgkmcnt(2)
    v_mfma_f32_32x32x16_bf16 v[80:95], v[120:123], v[8:11], v[80:95]
    ds_read_b128 v[100:103], v240 offset:50176
    v_mfma_f32_32x32x16_bf16 v[104:119], v[120:123], v[32:35], v[104:119]
    s_setprio 3
    v_cvt_pk_bf16_f32 v138, v56, v57
    v_cvt_pk_bf16_f32 v139, v58, v59
    v_cvt_pk_bf16_f32 v146, v60, v61
    v_cvt_pk_bf16_f32 v147, v62, v63
    s_setprio 1
    s_waitcnt lgkmcnt(2)
    v_mfma_f32_32x32x16_bf16 v[80:95], v[124:127], v[12:15], v[80:95]
    ds_read_b128 v[120:123], v240 offset:5120
    v_mfma_f32_32x32x16_bf16 v[104:119], v[124:127], v[36:39], v[104:119]
    s_setprio 3
    v_cvt_pk_bf16_f32 v128, v64, v65
    v_cvt_pk_bf16_f32 v129, v66, v67
    v_cvt_pk_bf16_f32 v130, v68, v69
    v_cvt_pk_bf16_f32 v131, v70, v71
    s_setprio 1
    s_waitcnt lgkmcnt(2)
    v_mfma_f32_32x32x16_bf16 v[80:95], v[96:99], v[16:19], v[80:95]
    ds_read_b128 v[124:127], v240 offset:14336
    v_mfma_f32_32x32x16_bf16 v[104:119], v[96:99], v[40:43], v[104:119]
    s_setprio 3
    v_cvt_pk_bf16_f32 v132, v72, v73
    v_cvt_pk_bf16_f32 v133, v74, v75
    v_cvt_pk_bf16_f32 v140, v76, v77
    v_cvt_pk_bf16_f32 v141, v78, v79
    s_setprio 1
    s_waitcnt lgkmcnt(2)
    v_mfma_f32_32x32x16_bf16 v[80:95], v[100:103], v[20:23], v[80:95]
    ds_read_b128 v[96:99], v240 offset:23552
    v_mfma_f32_32x32x16_bf16 v[104:119], v[100:103], v[44:47], v[104:119]
    s_waitcnt lgkmcnt(2)
    v_mfma_f32_32x32x16_bf16 v[48:63], v[120:123], v[0:3], 0
    ds_read_b128 v[100:103], v240 offset:32768
    v_mfma_f32_32x32x16_bf16 v[64:79], v[120:123], v[24:27], 0
    s_waitcnt lgkmcnt(2)
    v_mfma_f32_32x32x16_bf16 v[48:63], v[124:127], v[4:7], v[48:63]
    ds_read_b128 v[120:123], v240 offset:41984
    v_mfma_f32_32x32x16_bf16 v[64:79], v[124:127], v[28:31], v[64:79]
    s_setprio 3
    s_nop 0
    v_cvt_pk_bf16_f32 v148, v80, v81
    v_cvt_pk_bf16_f32 v149, v82, v83
    v_cvt_pk_bf16_f32 v150, v84, v85
    v_cvt_pk_bf16_f32 v151, v86, v87
    s_setprio 1
    s_waitcnt lgkmcnt(2)
    v_mfma_f32_32x32x16_bf16 v[48:63], v[96:99], v[8:11], v[48:63]
    ds_read_b128 v[124:127], v240 offset:51200
    v_mfma_f32_32x32x16_bf16 v[64:79], v[96:99], v[32:35], v[64:79]
    s_setprio 3
    v_cvt_pk_bf16_f32 v158, v88, v89
    v_cvt_pk_bf16_f32 v159, v90, v91
    v_cvt_pk_bf16_f32 v160, v92, v93
    v_cvt_pk_bf16_f32 v161, v94, v95
    s_setprio 1
    s_waitcnt lgkmcnt(2)
    v_mfma_f32_32x32x16_bf16 v[48:63], v[100:103], v[12:15], v[48:63]
    ds_read_b128 v[96:99], v240 offset:0
    v_mfma_f32_32x32x16_bf16 v[64:79], v[100:103], v[36:39], v[64:79]
    s_setprio 3
    v_cvt_pk_bf16_f32 v142, v104, v105
    v_cvt_pk_bf16_f32 v143, v106, v107
    v_cvt_pk_bf16_f32 v144, v108, v109
    v_cvt_pk_bf16_f32 v145, v110, v111
    s_setprio 1
    s_waitcnt lgkmcnt(2)
    v_mfma_f32_32x32x16_bf16 v[48:63], v[120:123], v[16:19], v[48:63]
    ds_read_b128 v[100:103], v240 offset:9216
    v_mfma_f32_32x32x16_bf16 v[64:79], v[120:123], v[40:43], v[64:79]
    s_setprio 3
    v_cvt_pk_bf16_f32 v152, v112, v113
    v_cvt_pk_bf16_f32 v153, v114, v115
    v_cvt_pk_bf16_f32 v154, v116, v117
    v_cvt_pk_bf16_f32 v155, v118, v119
    s_setprio 1
    s_waitcnt lgkmcnt(2)
    v_mfma_f32_32x32x16_bf16 v[48:63], v[124:127], v[20:23], v[48:63]
    ds_read_b128 v[120:123], v240 offset:18432
    v_mfma_f32_32x32x16_bf16 v[64:79], v[124:127], v[44:47], v[64:79]
    s_waitcnt lgkmcnt(2)
    v_mfma_f32_32x32x16_bf16 v[80:95], v[96:99], v[0:3], 0
    ds_read_b128 v[124:127], v240 offset:27648
    v_mfma_f32_32x32x16_bf16 v[104:119], v[96:99], v[24:27], 0
    s_waitcnt lgkmcnt(2)
    v_mfma_f32_32x32x16_bf16 v[80:95], v[100:103], v[4:7], v[80:95]
    ds_read_b128 v[96:99], v240 offset:36864
    v_mfma_f32_32x32x16_bf16 v[104:119], v[100:103], v[28:31], v[104:119]
    s_setprio 3
    s_nop 0
    v_cvt_pk_bf16_f32 v162, v48, v49
    v_cvt_pk_bf16_f32 v163, v50, v51
    v_cvt_pk_bf16_f32 v170, v52, v53
    v_cvt_pk_bf16_f32 v171, v54, v55
    s_setprio 1
    s_waitcnt lgkmcnt(2)
    v_mfma_f32_32x32x16_bf16 v[80:95], v[120:123], v[8:11], v[80:95]
    ds_read_b128 v[100:103], v240 offset:46080
    v_mfma_f32_32x32x16_bf16 v[104:119], v[120:123], v[32:35], v[104:119]
    s_setprio 3
    v_cvt_pk_bf16_f32 v172, v56, v57
    v_cvt_pk_bf16_f32 v173, v58, v59
    v_cvt_pk_bf16_f32 v174, v60, v61
    v_cvt_pk_bf16_f32 v175, v62, v63
    s_setprio 1
    s_waitcnt lgkmcnt(2)
    v_mfma_f32_32x32x16_bf16 v[80:95], v[124:127], v[12:15], v[80:95]
    ds_read_b128 v[120:123], v240 offset:1024
    v_mfma_f32_32x32x16_bf16 v[104:119], v[124:127], v[36:39], v[104:119]
    s_setprio 3
    v_cvt_pk_bf16_f32 v156, v64, v65
    v_cvt_pk_bf16_f32 v157, v66, v67
    v_cvt_pk_bf16_f32 v164, v68, v69
    v_cvt_pk_bf16_f32 v165, v70, v71
    s_setprio 1
    s_waitcnt lgkmcnt(2)
    v_mfma_f32_32x32x16_bf16 v[80:95], v[96:99], v[16:19], v[80:95]
    ds_read_b128 v[124:127], v240 offset:10240
    v_mfma_f32_32x32x16_bf16 v[104:119], v[96:99], v[40:43], v[104:119]
    s_setprio 3
    v_cvt_pk_bf16_f32 v166, v72, v73
    v_cvt_pk_bf16_f32 v167, v74, v75
    v_cvt_pk_bf16_f32 v168, v76, v77
    v_cvt_pk_bf16_f32 v169, v78, v79
    s_setprio 1
    s_waitcnt lgkmcnt(2)
    v_mfma_f32_32x32x16_bf16 v[80:95], v[100:103], v[20:23], v[80:95]
    ds_read_b128 v[96:99], v240 offset:19456
    v_mfma_f32_32x32x16_bf16 v[104:119], v[100:103], v[44:47], v[104:119]
    s_waitcnt lgkmcnt(2)
    v_mfma_f32_32x32x16_bf16 v[48:63], v[120:123], v[0:3], 0
    ds_read_b128 v[100:103], v240 offset:28672
    v_mfma_f32_32x32x16_bf16 v[64:79], v[120:123], v[24:27], 0
    s_waitcnt lgkmcnt(2)
    v_mfma_f32_32x32x16_bf16 v[48:63], v[124:127], v[4:7], v[48:63]
    ds_read_b128 v[120:123], v240 offset:37888
    v_mfma_f32_32x32x16_bf16 v[64:79], v[124:127], v[28:31], v[64:79]
    s_setprio 3
    s_nop 0
    v_cvt_pk_bf16_f32 v80, v80, v81
    v_cvt_pk_bf16_f32 v81, v82, v83
    v_cvt_pk_bf16_f32 v82, v84, v85
    v_cvt_pk_bf16_f32 v83, v86, v87
    s_setprio 1
    s_waitcnt lgkmcnt(2)
    v_mfma_f32_32x32x16_bf16 v[48:63], v[96:99], v[8:11], v[48:63]
    ds_read_b128 v[124:127], v240 offset:47104
    v_mfma_f32_32x32x16_bf16 v[64:79], v[96:99], v[32:35], v[64:79]
    s_setprio 3
    v_cvt_pk_bf16_f32 v84, v88, v89
    v_cvt_pk_bf16_f32 v85, v90, v91
    v_cvt_pk_bf16_f32 v86, v92, v93
    v_cvt_pk_bf16_f32 v87, v94, v95
    s_setprio 1
    s_waitcnt lgkmcnt(2)
    v_mfma_f32_32x32x16_bf16 v[48:63], v[100:103], v[12:15], v[48:63]
    ds_read_b128 v[96:99], v240 offset:2048
    v_mfma_f32_32x32x16_bf16 v[64:79], v[100:103], v[36:39], v[64:79]
    s_setprio 3
    v_cvt_pk_bf16_f32 v104, v104, v105
    v_cvt_pk_bf16_f32 v105, v106, v107
    v_cvt_pk_bf16_f32 v106, v108, v109
    v_cvt_pk_bf16_f32 v107, v110, v111
    s_setprio 1
    s_waitcnt lgkmcnt(2)
    v_mfma_f32_32x32x16_bf16 v[48:63], v[120:123], v[16:19], v[48:63]
    ds_read_b128 v[100:103], v240 offset:11264
    v_mfma_f32_32x32x16_bf16 v[64:79], v[120:123], v[40:43], v[64:79]
    s_setprio 3
    v_cvt_pk_bf16_f32 v108, v112, v113
    v_cvt_pk_bf16_f32 v109, v114, v115
    v_cvt_pk_bf16_f32 v110, v116, v117
    v_cvt_pk_bf16_f32 v111, v118, v119
    s_setprio 1
    s_waitcnt lgkmcnt(2)
    v_mfma_f32_32x32x16_bf16 v[48:63], v[124:127], v[20:23], v[48:63]
    ds_read_b128 v[120:123], v240 offset:20480
    v_mfma_f32_32x32x16_bf16 v[64:79], v[124:127], v[44:47], v[64:79]
    s_setprio 3
    s_nop 8
    v_cvt_pk_bf16_f32 v88, v48, v49
    v_cvt_pk_bf16_f32 v89, v50, v51
    v_cvt_pk_bf16_f32 v90, v52, v53
    v_cvt_pk_bf16_f32 v91, v54, v55
    v_cvt_pk_bf16_f32 v92, v56, v57
    v_cvt_pk_bf16_f32 v93, v58, v59
    v_cvt_pk_bf16_f32 v94, v60, v61
    v_cvt_pk_bf16_f32 v95, v62, v63
    v_cvt_pk_bf16_f32 v112, v64, v65
    v_cvt_pk_bf16_f32 v113, v66, v67
    v_cvt_pk_bf16_f32 v114, v68, v69
    v_cvt_pk_bf16_f32 v115, v70, v71
    v_cvt_pk_bf16_f32 v116, v72, v73
    v_cvt_pk_bf16_f32 v117, v74, v75
    v_cvt_pk_bf16_f32 v118, v76, v77
    v_cvt_pk_bf16_f32 v119, v78, v79
    s_setprio 1
    s_waitcnt lgkmcnt(2)
    v_mfma_f32_32x32x16_bf16 v[48:63], v[96:99], v[0:3], 0
    ds_read_b128 v[124:127], v240 offset:29696
    v_mfma_f32_32x32x16_bf16 v[64:79], v[96:99], v[24:27], 0
    s_waitcnt lgkmcnt(2)
    v_mfma_f32_32x32x16_bf16 v[48:63], v[100:103], v[4:7], v[48:63]
    ds_read_b128 v[96:99], v240 offset:38912
    v_mfma_f32_32x32x16_bf16 v[64:79], v[100:103], v[28:31], v[64:79]
    s_waitcnt lgkmcnt(2)
    v_mfma_f32_32x32x16_bf16 v[48:63], v[120:123], v[8:11], v[48:63]
    ds_read_b128 v[100:103], v240 offset:48128
    v_mfma_f32_32x32x16_bf16 v[64:79], v[120:123], v[32:35], v[64:79]
    s_waitcnt lgkmcnt(2)
    v_mfma_f32_32x32x16_bf16 v[48:63], v[124:127], v[12:15], v[48:63]
    v_mfma_f32_32x32x16_bf16 v[64:79], v[124:127], v[36:39], v[64:79]
    s_waitcnt lgkmcnt(1)
    v_mfma_f32_32x32x16_bf16 v[48:63], v[96:99], v[16:19], v[48:63]
    ds_read_b128 v[0:3], v242 offset:1152
    ds_read_b128 v[4:7], v242 offset:768
    ds_read_b128 v[8:11], v242 offset:384
    ds_read_b128 v[12:15], v242 offset:0
    v_mfma_f32_32x32x16_bf16 v[64:79], v[96:99], v[40:43], v[64:79]
    s_waitcnt lgkmcnt(4)
    v_mfma_f32_32x32x16_bf16 v[48:63], v[100:103], v[20:23], v[48:63]
    v_mfma_f32_32x32x16_bf16 v[64:79], v[100:103], v[44:47], v[64:79]
    s_setprio 2
    ds_read_b128 v[16:19], v241 offset:2688
    ds_read_b128 v[20:23], v241 offset:2304
    ds_read_b128 v[24:27], v241 offset:1920
    ds_read_b128 v[28:31], v241 offset:1536
    s_waitcnt lgkmcnt(4)
    v_mfma_f32_32x32x16_bf16 v[0:15], v[128:131], v[80:83], v[0:15]
    s_nop 3
    v_cvt_pk_bf16_f32 v96, v48, v49
    v_cvt_pk_bf16_f32 v97, v50, v51
    v_cvt_pk_bf16_f32 v98, v52, v53
    v_cvt_pk_bf16_f32 v99, v54, v55
    v_mfma_f32_32x32x8_bf16 v[0:15], v[132:133], v[84:85], v[0:15]
    v_cvt_pk_bf16_f32 v100, v56, v57
    v_cvt_pk_bf16_f32 v101, v58, v59
    v_cvt_pk_bf16_f32 v102, v60, v61
    v_cvt_pk_bf16_f32 v103, v62, v63
    v_cvt_pk_bf16_f32 v120, v64, v65
    v_cvt_pk_bf16_f32 v121, v66, v67
    v_cvt_pk_bf16_f32 v122, v68, v69
    v_cvt_pk_bf16_f32 v123, v70, v71
    v_cvt_pk_bf16_f32 v124, v72, v73
    v_cvt_pk_bf16_f32 v125, v74, v75
    v_cvt_pk_bf16_f32 v126, v76, v77
    v_cvt_pk_bf16_f32 v127, v78, v79
    v_exp_f32_e32 v0, v0
    v_exp_f32_e32 v1, v1
    v_exp_f32_e32 v2, v2
    s_waitcnt lgkmcnt(0)
    v_mfma_f32_32x32x16_bf16 v[32:47], v[128:131], v[104:107], v[16:31]
    v_exp_f32_e32 v3, v3
    v_cvt_pk_bf16_f32 v0, v0, v1
    v_exp_f32_e32 v4, v4
    v_exp_f32_e32 v5, v5
    v_cvt_pk_bf16_f32 v1, v2, v3
    v_mfma_f32_32x32x16_bf16 v[16:31], v[134:137], v[80:83], v[16:31]
    v_exp_f32_e32 v6, v6
    v_exp_f32_e32 v7, v7
    v_cvt_pk_bf16_f32 v2, v4, v5
    v_exp_f32_e32 v8, v8
    v_exp_f32_e32 v9, v9
    v_mfma_f32_32x32x8_bf16 v[16:31], v[138:139], v[84:85], v[16:31]
    v_cvt_pk_bf16_f32 v3, v6, v7
    v_exp_f32_e32 v10, v10
    v_exp_f32_e32 v11, v11
    v_cvt_pk_bf16_f32 v4, v8, v9
    v_exp_f32_e32 v12, v12
    v_exp_f32_e32 v13, v13
    v_cvt_pk_bf16_f32 v5, v10, v11
    v_exp_f32_e32 v14, v14
    v_exp_f32_e32 v15, v15
    v_cvt_pk_bf16_f32 v6, v12, v13
    v_cvt_pk_bf16_f32 v7, v14, v15
    v_mfma_f32_32x32x16_bf16 v[64:79], v[184:187], v[0:3], 0
    ds_read_b128 v[48:51], v242 offset:4224
    ds_read_b128 v[52:55], v242 offset:3840
    v_exp_f32_e32 v16, v16
    v_exp_f32_e32 v17, v17
    v_exp_f32_e32 v18, v18
    v_exp_f32_e32 v19, v19
    v_cvt_pk_bf16_f32 v16, v16, v17
    v_exp_f32_e32 v20, v20
    v_mfma_f32_32x32x16_bf16 v[64:79], v[188:191], v[4:7], v[64:79]
    ds_read_b128 v[56:59], v242 offset:3456
    ds_read_b128 v[60:63], v242 offset:3072
    v_exp_f32_e32 v21, v21
    v_cvt_pk_bf16_f32 v17, v18, v19
    v_exp_f32_e32 v22, v22
    v_exp_f32_e32 v23, v23
    v_cvt_pk_bf16_f32 v18, v20, v21
    v_exp_f32_e32 v24, v24
    v_mfma_f32_32x32x8_bf16 v[32:47], v[132:133], v[108:109], v[32:47]
    v_exp_f32_e32 v25, v25
    v_cvt_pk_bf16_f32 v19, v22, v23
    v_exp_f32_e32 v26, v26
    v_exp_f32_e32 v27, v27
    v_cvt_pk_bf16_f32 v20, v24, v25
    v_exp_f32_e32 v28, v28
    v_exp_f32_e32 v29, v29
    v_cvt_pk_bf16_f32 v21, v26, v27
    v_exp_f32_e32 v30, v30
    v_exp_f32_e32 v31, v31
    v_cvt_pk_bf16_f32 v22, v28, v29
    v_cvt_pk_bf16_f32 v23, v30, v31
    v_mfma_f32_32x32x16_bf16 v[64:79], v[176:179], v[16:19], v[64:79]
    ds_read_b128 v[0:3], v242 offset:1344
    v_exp_f32_e32 v32, v32
    v_exp_f32_e32 v33, v33
    v_exp_f32_e32 v34, v34
    v_exp_f32_e32 v35, v35
    v_cvt_pk_bf16_f32 v32, v32, v33
    v_mfma_f32_32x32x16_bf16 v[64:79], v[180:183], v[20:23], v[64:79]
    ds_read_b128 v[4:7], v242 offset:960
    v_exp_f32_e32 v36, v36
    v_exp_f32_e32 v37, v37
    v_cvt_pk_bf16_f32 v33, v34, v35
    v_exp_f32_e32 v38, v38
    v_exp_f32_e32 v39, v39
    s_waitcnt lgkmcnt(2)
    v_mfma_f32_32x32x16_bf16 v[48:63], v[134:137], v[104:107], v[48:63]
    ds_read_b128 v[8:11], v242 offset:576
    v_cvt_pk_bf16_f32 v34, v36, v37
    v_exp_f32_e32 v40, v40
    v_exp_f32_e32 v41, v41
    v_cvt_pk_bf16_f32 v35, v38, v39
    v_exp_f32_e32 v42, v42
    v_mfma_f32_32x32x8_bf16 v[48:63], v[138:139], v[108:109], v[48:63]
    ds_read_b128 v[12:15], v242 offset:192
    v_exp_f32_e32 v43, v43
    v_cvt_pk_bf16_f32 v36, v40, v41
    v_exp_f32_e32 v44, v44
    v_exp_f32_e32 v45, v45
    v_cvt_pk_bf16_f32 v37, v42, v43
    v_exp_f32_e32 v46, v46
    v_exp_f32_e32 v47, v47
    v_cvt_pk_bf16_f32 v38, v44, v45
    v_rcp_f32_e32 v252, v64
    v_cvt_pk_bf16_f32 v39, v46, v47
    v_mul_f32_e32 v68, v68, v252
    v_mul_f32_e32 v69, v69, v252
    v_mul_f32_e32 v70, v70, v252
    v_mul_f32_e32 v71, v71, v252
    v_mul_f32_e32 v72, v72, v252
    v_mul_f32_e32 v73, v73, v252
    v_mul_f32_e32 v74, v74, v252
    v_mul_f32_e32 v75, v75, v252
    v_mul_f32_e32 v76, v76, v252
    v_mul_f32_e32 v77, v77, v252
    v_mul_f32_e32 v78, v78, v252
    v_mul_f32_e32 v79, v79, v252
    v_max_f32_e64 v250, v64, v252
    v_cvt_pk_bf16_f32 v80, v68, v69
    v_cvt_pk_bf16_f32 v81, v70, v71
    v_cvt_pk_bf16_f32 v82, v72, v73
    v_cvt_pk_bf16_f32 v83, v74, v75
    v_cvt_pk_bf16_f32 v84, v76, v77
    v_cvt_pk_bf16_f32 v85, v78, v79
    v_mfma_f32_32x32x16_bf16 v[64:79], v[184:187], v[32:35], 0
    ds_read_b128 v[16:19], v241 offset:2880
    v_exp_f32_e32 v48, v48
    v_exp_f32_e32 v49, v49
    v_exp_f32_e32 v50, v50
    v_exp_f32_e32 v51, v51
    v_cvt_pk_bf16_f32 v48, v48, v49
    v_mfma_f32_32x32x16_bf16 v[64:79], v[188:191], v[36:39], v[64:79]
    ds_read_b128 v[20:23], v241 offset:2496
    v_exp_f32_e32 v52, v52
    v_exp_f32_e32 v53, v53
    v_cvt_pk_bf16_f32 v49, v50, v51
    v_exp_f32_e32 v54, v54
    v_exp_f32_e32 v55, v55
    s_waitcnt lgkmcnt(2)
    v_mfma_f32_32x32x16_bf16 v[0:15], v[140:143], v[86:89], v[0:15]
    ds_read_b128 v[24:27], v241 offset:2112
    v_cvt_pk_bf16_f32 v50, v52, v53
    v_exp_f32_e32 v56, v56
    v_exp_f32_e32 v57, v57
    v_cvt_pk_bf16_f32 v51, v54, v55
    v_exp_f32_e32 v58, v58
    v_mfma_f32_32x32x8_bf16 v[0:15], v[144:145], v[90:91], v[0:15]
    ds_read_b128 v[28:31], v241 offset:1728
    v_exp_f32_e32 v59, v59
    v_cvt_pk_bf16_f32 v52, v56, v57
    v_exp_f32_e32 v60, v60
    v_exp_f32_e32 v61, v61
    v_cvt_pk_bf16_f32 v53, v58, v59
    v_exp_f32_e32 v62, v62
    v_exp_f32_e32 v63, v63
    v_cvt_pk_bf16_f32 v54, v60, v61
    v_cvt_pk_bf16_f32 v55, v62, v63
    v_mfma_f32_32x32x16_bf16 v[64:79], v[176:179], v[48:51], v[64:79]
    s_nop 0
    v_exp_f32_e32 v0, v0
    v_exp_f32_e32 v1, v1
    v_exp_f32_e32 v2, v2
    v_exp_f32_e32 v3, v3
    v_mfma_f32_32x32x16_bf16 v[64:79], v[180:183], v[52:55], v[64:79]
    v_cvt_pk_bf16_f32 v0, v0, v1
    v_exp_f32_e32 v4, v4
    v_exp_f32_e32 v5, v5
    v_cvt_pk_bf16_f32 v1, v2, v3
    s_waitcnt lgkmcnt(0)
    v_mfma_f32_32x32x16_bf16 v[32:47], v[140:143], v[110:113], v[16:31]
    v_exp_f32_e32 v6, v6
    v_exp_f32_e32 v7, v7
    v_cvt_pk_bf16_f32 v2, v4, v5
    v_exp_f32_e32 v8, v8
    v_mfma_f32_32x32x16_bf16 v[16:31], v[146:149], v[86:89], v[16:31]
    v_exp_f32_e32 v9, v9
    v_cvt_pk_bf16_f32 v3, v6, v7
    v_exp_f32_e32 v10, v10
    v_exp_f32_e32 v11, v11
    v_mfma_f32_32x32x8_bf16 v[16:31], v[150:151], v[90:91], v[16:31]
    v_cvt_pk_bf16_f32 v4, v8, v9
    v_exp_f32_e32 v12, v12
    v_exp_f32_e32 v13, v13
    v_cvt_pk_bf16_f32 v5, v10, v11
    v_exp_f32_e32 v14, v14
    v_exp_f32_e32 v15, v15
    v_cvt_pk_bf16_f32 v6, v12, v13
    v_rcp_f32_e32 v252, v64
    v_cvt_pk_bf16_f32 v7, v14, v15
    v_mul_f32_e32 v68, v68, v252
    v_mul_f32_e32 v69, v69, v252
    v_mul_f32_e32 v70, v70, v252
    v_mul_f32_e32 v71, v71, v252
    v_mul_f32_e32 v72, v72, v252
    v_mul_f32_e32 v73, v73, v252
    v_mul_f32_e32 v74, v74, v252
    v_mul_f32_e32 v75, v75, v252
    v_mul_f32_e32 v76, v76, v252
    v_mul_f32_e32 v77, v77, v252
    v_mul_f32_e32 v78, v78, v252
    v_mul_f32_e32 v79, v79, v252
    v_max3_f32 v250, v250, v64, v252
    v_cvt_pk_bf16_f32 v104, v68, v69
    v_cvt_pk_bf16_f32 v105, v70, v71
    v_cvt_pk_bf16_f32 v106, v72, v73
    v_cvt_pk_bf16_f32 v107, v74, v75
    v_cvt_pk_bf16_f32 v108, v76, v77
    v_cvt_pk_bf16_f32 v109, v78, v79
    v_mfma_f32_32x32x16_bf16 v[64:79], v[200:203], v[0:3], 0
    ds_read_b128 v[48:51], v242 offset:4416
    ds_read_b128 v[52:55], v242 offset:4032
    v_exp_f32_e32 v16, v16
    v_exp_f32_e32 v17, v17
    v_exp_f32_e32 v18, v18
    v_exp_f32_e32 v19, v19
    v_cvt_pk_bf16_f32 v16, v16, v17
    v_exp_f32_e32 v20, v20
    v_mfma_f32_32x32x16_bf16 v[64:79], v[204:207], v[4:7], v[64:79]
    ds_read_b128 v[56:59], v242 offset:3648
    ds_read_b128 v[60:63], v242 offset:3264
    v_exp_f32_e32 v21, v21
    v_cvt_pk_bf16_f32 v17, v18, v19
    v_exp_f32_e32 v22, v22
    v_exp_f32_e32 v23, v23
    v_cvt_pk_bf16_f32 v18, v20, v21
    v_exp_f32_e32 v24, v24
    v_mfma_f32_32x32x8_bf16 v[32:47], v[144:145], v[114:115], v[32:47]
    v_exp_f32_e32 v25, v25
    v_cvt_pk_bf16_f32 v19, v22, v23
    v_exp_f32_e32 v26, v26
    v_exp_f32_e32 v27, v27
    v_cvt_pk_bf16_f32 v20, v24, v25
    v_exp_f32_e32 v28, v28
    v_exp_f32_e32 v29, v29
    v_cvt_pk_bf16_f32 v21, v26, v27
    v_exp_f32_e32 v30, v30
    v_exp_f32_e32 v31, v31
    v_cvt_pk_bf16_f32 v22, v28, v29
    v_cvt_pk_bf16_f32 v23, v30, v31
    v_mfma_f32_32x32x16_bf16 v[64:79], v[192:195], v[16:19], v[64:79]
    ds_read_b128 v[128:131], v242 offset:6912
    v_exp_f32_e32 v32, v32
    v_exp_f32_e32 v33, v33
    v_exp_f32_e32 v34, v34
    v_exp_f32_e32 v35, v35
    v_cvt_pk_bf16_f32 v32, v32, v33
    v_mfma_f32_32x32x16_bf16 v[64:79], v[196:199], v[20:23], v[64:79]
    ds_read_b128 v[132:135], v242 offset:6528
    v_exp_f32_e32 v36, v36
    v_exp_f32_e32 v37, v37
    v_cvt_pk_bf16_f32 v33, v34, v35
    v_exp_f32_e32 v38, v38
    v_exp_f32_e32 v39, v39
    s_waitcnt lgkmcnt(2)
    v_mfma_f32_32x32x16_bf16 v[48:63], v[146:149], v[110:113], v[48:63]
    ds_read_b128 v[136:139], v242 offset:6144
    v_cvt_pk_bf16_f32 v34, v36, v37
    v_exp_f32_e32 v40, v40
    v_exp_f32_e32 v41, v41
    v_cvt_pk_bf16_f32 v35, v38, v39
    v_exp_f32_e32 v42, v42
    v_mfma_f32_32x32x8_bf16 v[48:63], v[150:151], v[114:115], v[48:63]
    ds_read_b128 v[140:143], v242 offset:5760
    v_exp_f32_e32 v43, v43
    v_cvt_pk_bf16_f32 v36, v40, v41
    v_exp_f32_e32 v44, v44
    v_exp_f32_e32 v45, v45
    v_cvt_pk_bf16_f32 v37, v42, v43
    v_exp_f32_e32 v46, v46
    v_exp_f32_e32 v47, v47
    v_cvt_pk_bf16_f32 v38, v44, v45
    v_rcp_f32_e32 v252, v68
    v_cvt_pk_bf16_f32 v39, v46, v47
    v_mul_f32_e32 v64, v64, v252
    v_mul_f32_e32 v65, v65, v252
    v_mul_f32_e32 v66, v66, v252
    v_mul_f32_e32 v67, v67, v252
    v_mul_f32_e32 v72, v72, v252
    v_mul_f32_e32 v73, v73, v252
    v_mul_f32_e32 v74, v74, v252
    v_mul_f32_e32 v75, v75, v252
    v_mul_f32_e32 v76, v76, v252
    v_mul_f32_e32 v77, v77, v252
    v_mul_f32_e32 v78, v78, v252
    v_mul_f32_e32 v79, v79, v252
    v_max3_f32 v250, v250, v68, v252
    v_cvt_pk_bf16_f32 v86, v64, v65
    v_cvt_pk_bf16_f32 v87, v66, v67
    v_cvt_pk_bf16_f32 v88, v72, v73
    v_cvt_pk_bf16_f32 v89, v74, v75
    v_cvt_pk_bf16_f32 v90, v76, v77
    v_cvt_pk_bf16_f32 v91, v78, v79
    v_mfma_f32_32x32x16_bf16 v[64:79], v[200:203], v[32:35], 0
    ds_read_b128 v[16:19], v241 offset:8448
    ds_read_b128 v[20:23], v241 offset:8064
    v_exp_f32_e32 v48, v48
    v_exp_f32_e32 v49, v49
    v_exp_f32_e32 v50, v50
    v_exp_f32_e32 v51, v51
    v_cvt_pk_bf16_f32 v48, v48, v49
    v_mfma_f32_32x32x16_bf16 v[64:79], v[204:207], v[36:39], v[64:79]
    ds_read_b128 v[24:27], v241 offset:7680
    ds_read_b128 v[28:31], v241 offset:7296
    v_exp_f32_e32 v52, v52
    v_exp_f32_e32 v53, v53
    v_cvt_pk_bf16_f32 v49, v50, v51
    v_exp_f32_e32 v54, v54
    v_exp_f32_e32 v55, v55
    s_waitcnt lgkmcnt(4)
    v_mfma_f32_32x32x16_bf16 v[128:143], v[152:155], v[92:95], v[128:143]
    v_add_u32 v254, 55296, v240
    v_cvt_pk_bf16_f32 v50, v52, v53
    v_exp_f32_e32 v56, v56
    v_exp_f32_e32 v57, v57
    v_cvt_pk_bf16_f32 v51, v54, v55
    v_exp_f32_e32 v58, v58
    v_mfma_f32_32x32x8_bf16 v[128:143], v[156:157], v[96:97], v[128:143]
    v_exp_f32_e32 v59, v59
    v_cvt_pk_bf16_f32 v52, v56, v57
    v_exp_f32_e32 v60, v60
    v_exp_f32_e32 v61, v61
    v_cvt_pk_bf16_f32 v53, v58, v59
    v_exp_f32_e32 v62, v62
    v_exp_f32_e32 v63, v63
    v_cvt_pk_bf16_f32 v54, v60, v61
    v_cvt_pk_bf16_f32 v55, v62, v63
    v_mfma_f32_32x32x16_bf16 v[64:79], v[192:195], v[48:51], v[64:79]
    ds_read_b128 v[0:3], v254 offset:0
    s_nop 0
    v_exp_f32_e32 v128, v128
    v_exp_f32_e32 v129, v129
    v_exp_f32_e32 v130, v130
    v_exp_f32_e32 v131, v131
    v_mfma_f32_32x32x16_bf16 v[64:79], v[196:199], v[52:55], v[64:79]
    ds_read_b128 v[4:7], v254 offset:3072
    v_cvt_pk_bf16_f32 v128, v128, v129
    v_exp_f32_e32 v132, v132
    v_exp_f32_e32 v133, v133
    v_cvt_pk_bf16_f32 v129, v130, v131
    s_waitcnt lgkmcnt(2)
    v_mfma_f32_32x32x16_bf16 v[32:47], v[152:155], v[116:119], v[16:31]
    ds_read_b128 v[8:11], v254 offset:6144
    v_exp_f32_e32 v134, v134
    v_exp_f32_e32 v135, v135
    v_cvt_pk_bf16_f32 v130, v132, v133
    v_exp_f32_e32 v136, v136
    v_mfma_f32_32x32x16_bf16 v[16:31], v[158:161], v[92:95], v[16:31]
    ds_read_b128 v[12:15], v254 offset:9216
    v_exp_f32_e32 v137, v137
    v_cvt_pk_bf16_f32 v131, v134, v135
    v_exp_f32_e32 v138, v138
    v_exp_f32_e32 v139, v139
    v_mfma_f32_32x32x8_bf16 v[16:31], v[162:163], v[96:97], v[16:31]
    v_cvt_pk_bf16_f32 v132, v136, v137
    v_exp_f32_e32 v140, v140
    v_exp_f32_e32 v141, v141
    v_cvt_pk_bf16_f32 v133, v138, v139
    v_exp_f32_e32 v142, v142
    v_exp_f32_e32 v143, v143
    v_cvt_pk_bf16_f32 v134, v140, v141
    v_rcp_f32_e32 v252, v68
    v_cvt_pk_bf16_f32 v135, v142, v143
    v_mul_f32_e32 v64, v64, v252
    v_mul_f32_e32 v65, v65, v252
    v_mul_f32_e32 v66, v66, v252
    v_mul_f32_e32 v67, v67, v252
    v_mul_f32_e32 v72, v72, v252
    v_mul_f32_e32 v73, v73, v252
    v_mul_f32_e32 v74, v74, v252
    v_mul_f32_e32 v75, v75, v252
    v_mul_f32_e32 v76, v76, v252
    v_mul_f32_e32 v77, v77, v252
    v_mul_f32_e32 v78, v78, v252
    v_mul_f32_e32 v79, v79, v252
    v_max3_f32 v250, v250, v68, v252
    v_cvt_pk_bf16_f32 v110, v64, v65
    v_cvt_pk_bf16_f32 v111, v66, v67
    v_cvt_pk_bf16_f32 v112, v72, v73
    v_cvt_pk_bf16_f32 v113, v74, v75
    v_cvt_pk_bf16_f32 v114, v76, v77
    v_cvt_pk_bf16_f32 v115, v78, v79
    v_mfma_f32_32x32x16_bf16 v[64:79], v[216:219], v[128:131], 0
    ds_read_b128 v[48:51], v242 offset:9984
    ds_read_b128 v[52:55], v242 offset:9600
    v_exp_f32_e32 v16, v16
    v_exp_f32_e32 v17, v17
    v_exp_f32_e32 v18, v18
    v_exp_f32_e32 v19, v19
    v_cvt_pk_bf16_f32 v16, v16, v17
    v_exp_f32_e32 v20, v20
    v_mfma_f32_32x32x16_bf16 v[64:79], v[220:223], v[132:135], v[64:79]
    ds_read_b128 v[56:59], v242 offset:9216
    ds_read_b128 v[60:63], v242 offset:8832
    v_exp_f32_e32 v21, v21
    v_cvt_pk_bf16_f32 v17, v18, v19
    v_exp_f32_e32 v22, v22
    v_exp_f32_e32 v23, v23
    v_cvt_pk_bf16_f32 v18, v20, v21
    v_exp_f32_e32 v24, v24
    v_mfma_f32_32x32x8_bf16 v[32:47], v[156:157], v[120:121], v[32:47]
    v_exp_f32_e32 v25, v25
    v_cvt_pk_bf16_f32 v19, v22, v23
    v_exp_f32_e32 v26, v26
    v_exp_f32_e32 v27, v27
    v_cvt_pk_bf16_f32 v20, v24, v25
    v_exp_f32_e32 v28, v28
    v_exp_f32_e32 v29, v29
    v_cvt_pk_bf16_f32 v21, v26, v27
    v_exp_f32_e32 v30, v30
    v_exp_f32_e32 v31, v31
    v_cvt_pk_bf16_f32 v22, v28, v29
    v_cvt_pk_bf16_f32 v23, v30, v31
    v_mfma_f32_32x32x16_bf16 v[64:79], v[208:211], v[16:19], v[64:79]
    ds_read_b128 v[128:131], v242 offset:7104
    v_exp_f32_e32 v32, v32
    v_exp_f32_e32 v33, v33
    v_exp_f32_e32 v34, v34
    v_exp_f32_e32 v35, v35
    v_cvt_pk_bf16_f32 v32, v32, v33
    v_mfma_f32_32x32x16_bf16 v[64:79], v[212:215], v[20:23], v[64:79]
    ds_read_b128 v[132:135], v242 offset:6720
    v_exp_f32_e32 v36, v36
    v_exp_f32_e32 v37, v37
    v_cvt_pk_bf16_f32 v33, v34, v35
    v_exp_f32_e32 v38, v38
    v_exp_f32_e32 v39, v39
    s_waitcnt lgkmcnt(2)
    v_mfma_f32_32x32x16_bf16 v[48:63], v[158:161], v[116:119], v[48:63]
    ds_read_b128 v[136:139], v242 offset:6336
    v_cvt_pk_bf16_f32 v34, v36, v37
    v_exp_f32_e32 v40, v40
    v_exp_f32_e32 v41, v41
    v_cvt_pk_bf16_f32 v35, v38, v39
    v_exp_f32_e32 v42, v42
    v_mfma_f32_32x32x8_bf16 v[48:63], v[162:163], v[120:121], v[48:63]
    ds_read_b128 v[140:143], v242 offset:5952
    v_exp_f32_e32 v43, v43
    v_cvt_pk_bf16_f32 v36, v40, v41
    v_exp_f32_e32 v44, v44
    v_exp_f32_e32 v45, v45
    v_cvt_pk_bf16_f32 v37, v42, v43
    v_exp_f32_e32 v46, v46
    v_exp_f32_e32 v47, v47
    v_cvt_pk_bf16_f32 v38, v44, v45
    v_rcp_f32_e32 v252, v72
    v_cvt_pk_bf16_f32 v39, v46, v47
    v_mul_f32_e32 v64, v64, v252
    v_mul_f32_e32 v65, v65, v252
    v_mul_f32_e32 v66, v66, v252
    v_mul_f32_e32 v67, v67, v252
    v_mul_f32_e32 v68, v68, v252
    v_mul_f32_e32 v69, v69, v252
    v_mul_f32_e32 v70, v70, v252
    v_mul_f32_e32 v71, v71, v252
    v_mul_f32_e32 v76, v76, v252
    v_mul_f32_e32 v77, v77, v252
    v_mul_f32_e32 v78, v78, v252
    v_mul_f32_e32 v79, v79, v252
    v_max3_f32 v250, v250, v72, v252
    v_cvt_pk_bf16_f32 v92, v64, v65
    v_cvt_pk_bf16_f32 v93, v66, v67
    v_cvt_pk_bf16_f32 v94, v68, v69
    v_cvt_pk_bf16_f32 v95, v70, v71
    v_cvt_pk_bf16_f32 v96, v76, v77
    v_cvt_pk_bf16_f32 v97, v78, v79
    v_mfma_f32_32x32x16_bf16 v[64:79], v[216:219], v[32:35], 0
    ds_read_b128 v[144:147], v241 offset:8640
    v_exp_f32_e32 v48, v48
    v_exp_f32_e32 v49, v49
    v_exp_f32_e32 v50, v50
    v_exp_f32_e32 v51, v51
    v_cvt_pk_bf16_f32 v48, v48, v49
    v_mfma_f32_32x32x16_bf16 v[64:79], v[220:223], v[36:39], v[64:79]
    ds_read_b128 v[148:151], v241 offset:8256
    v_exp_f32_e32 v52, v52
    v_exp_f32_e32 v53, v53
    v_cvt_pk_bf16_f32 v49, v50, v51
    v_exp_f32_e32 v54, v54
    v_exp_f32_e32 v55, v55
    s_waitcnt lgkmcnt(2)
    v_mfma_f32_32x32x16_bf16 v[128:143], v[164:167], v[98:101], v[128:143]
    ds_read_b128 v[152:155], v241 offset:7872
    v_cvt_pk_bf16_f32 v50, v52, v53
    v_exp_f32_e32 v56, v56
    v_exp_f32_e32 v57, v57
    v_cvt_pk_bf16_f32 v51, v54, v55
    v_exp_f32_e32 v58, v58
    v_mfma_f32_32x32x8_bf16 v[128:143], v[168:169], v[102:103], v[128:143]
    ds_read_b128 v[156:159], v241 offset:7488
    v_exp_f32_e32 v59, v59
    v_cvt_pk_bf16_f32 v52, v56, v57
    v_exp_f32_e32 v60, v60
    v_exp_f32_e32 v61, v61
    v_cvt_pk_bf16_f32 v53, v58, v59
    v_exp_f32_e32 v62, v62
    v_exp_f32_e32 v63, v63
    v_cvt_pk_bf16_f32 v54, v60, v61
    v_cvt_pk_bf16_f32 v55, v62, v63
    v_mfma_f32_32x32x16_bf16 v[64:79], v[208:211], v[48:51], v[64:79]
    ds_read_b128 v[16:19], v254 offset:12288
    v_exp_f32_e32 v128, v128
    v_exp_f32_e32 v129, v129
    v_exp_f32_e32 v130, v130
    v_exp_f32_e32 v131, v131
    v_mfma_f32_32x32x16_bf16 v[64:79], v[212:215], v[52:55], v[64:79]
    ds_read_b128 v[20:23], v254 offset:15360
    v_cvt_pk_bf16_f32 v128, v128, v129
    v_exp_f32_e32 v132, v132
    v_exp_f32_e32 v133, v133
    v_cvt_pk_bf16_f32 v129, v130, v131
    s_waitcnt lgkmcnt(2)
    v_mfma_f32_32x32x16_bf16 v[32:47], v[164:167], v[122:125], v[144:159]
    ds_read_b128 v[24:27], v254 offset:1024
    v_exp_f32_e32 v134, v134
    v_exp_f32_e32 v135, v135
    v_cvt_pk_bf16_f32 v130, v132, v133
    v_exp_f32_e32 v136, v136
    v_mfma_f32_32x32x16_bf16 v[144:159], v[170:173], v[98:101], v[144:159]
    ds_read_b128 v[28:31], v254 offset:4096
    v_exp_f32_e32 v137, v137
    v_cvt_pk_bf16_f32 v131, v134, v135
    v_exp_f32_e32 v138, v138
    v_exp_f32_e32 v139, v139
    v_mfma_f32_32x32x8_bf16 v[144:159], v[174:175], v[102:103], v[144:159]
    v_cvt_pk_bf16_f32 v132, v136, v137
    v_exp_f32_e32 v140, v140
    v_exp_f32_e32 v141, v141
    v_cvt_pk_bf16_f32 v133, v138, v139
    v_exp_f32_e32 v142, v142
    v_exp_f32_e32 v143, v143
    v_cvt_pk_bf16_f32 v134, v140, v141
    v_rcp_f32_e32 v252, v72
    v_cvt_pk_bf16_f32 v135, v142, v143
    v_mul_f32_e32 v64, v64, v252
    v_mul_f32_e32 v65, v65, v252
    v_mul_f32_e32 v66, v66, v252
    v_mul_f32_e32 v67, v67, v252
    v_mul_f32_e32 v68, v68, v252
    v_mul_f32_e32 v69, v69, v252
    v_mul_f32_e32 v70, v70, v252
    v_mul_f32_e32 v71, v71, v252
    v_mul_f32_e32 v76, v76, v252
    v_mul_f32_e32 v77, v77, v252
    v_mul_f32_e32 v78, v78, v252
    v_mul_f32_e32 v79, v79, v252
    v_max3_f32 v250, v250, v72, v252
    v_cvt_pk_bf16_f32 v116, v64, v65
    v_cvt_pk_bf16_f32 v117, v66, v67
    v_cvt_pk_bf16_f32 v118, v68, v69
    v_cvt_pk_bf16_f32 v119, v70, v71
    v_cvt_pk_bf16_f32 v120, v76, v77
    v_cvt_pk_bf16_f32 v121, v78, v79
    v_mfma_f32_32x32x16_bf16 v[64:79], v[232:235], v[128:131], 0
    ds_read_b128 v[48:51], v242 offset:10176
    ds_read_b128 v[52:55], v242 offset:9792
    v_exp_f32_e32 v144, v144
    v_exp_f32_e32 v145, v145
    v_exp_f32_e32 v146, v146
    v_exp_f32_e32 v147, v147
    v_cvt_pk_bf16_f32 v144, v144, v145
    v_exp_f32_e32 v148, v148
    v_mfma_f32_32x32x16_bf16 v[64:79], v[236:239], v[132:135], v[64:79]
    ds_read_b128 v[56:59], v242 offset:9408
    ds_read_b128 v[60:63], v242 offset:9024
    v_exp_f32_e32 v149, v149
    v_cvt_pk_bf16_f32 v145, v146, v147
    v_exp_f32_e32 v150, v150
    v_exp_f32_e32 v151, v151
    v_cvt_pk_bf16_f32 v146, v148, v149
    v_exp_f32_e32 v152, v152
    v_mfma_f32_32x32x8_bf16 v[32:47], v[168:169], v[126:127], v[32:47]
    v_exp_f32_e32 v153, v153
    v_cvt_pk_bf16_f32 v147, v150, v151
    v_exp_f32_e32 v154, v154
    v_exp_f32_e32 v155, v155
    v_cvt_pk_bf16_f32 v148, v152, v153
    v_exp_f32_e32 v156, v156
    v_exp_f32_e32 v157, v157
    v_cvt_pk_bf16_f32 v149, v154, v155
    v_exp_f32_e32 v158, v158
    v_exp_f32_e32 v159, v159
    v_cvt_pk_bf16_f32 v150, v156, v157
    v_cvt_pk_bf16_f32 v151, v158, v159
    v_mfma_f32_32x32x16_bf16 v[64:79], v[224:227], v[144:147], v[64:79]
    v_exp_f32_e32 v32, v32
    v_exp_f32_e32 v33, v33
    v_exp_f32_e32 v34, v34
    v_exp_f32_e32 v35, v35
    v_cvt_pk_bf16_f32 v32, v32, v33
    v_mfma_f32_32x32x16_bf16 v[64:79], v[228:231], v[148:151], v[64:79]
    v_exp_f32_e32 v36, v36
    v_exp_f32_e32 v37, v37
    v_cvt_pk_bf16_f32 v33, v34, v35
    v_exp_f32_e32 v38, v38
    v_exp_f32_e32 v39, v39
    s_waitcnt lgkmcnt(0)
    v_mfma_f32_32x32x16_bf16 v[48:63], v[170:173], v[122:125], v[48:63]
    v_cvt_pk_bf16_f32 v34, v36, v37
    v_exp_f32_e32 v40, v40
    v_exp_f32_e32 v41, v41
    v_cvt_pk_bf16_f32 v35, v38, v39
    v_exp_f32_e32 v42, v42
    v_mfma_f32_32x32x8_bf16 v[48:63], v[174:175], v[126:127], v[48:63]
    v_exp_f32_e32 v43, v43
    v_cvt_pk_bf16_f32 v36, v40, v41
    v_exp_f32_e32 v44, v44
    v_exp_f32_e32 v45, v45
    v_cvt_pk_bf16_f32 v37, v42, v43
    v_exp_f32_e32 v46, v46
    v_exp_f32_e32 v47, v47
    v_cvt_pk_bf16_f32 v38, v44, v45
    v_rcp_f32_e32 v252, v76
    v_cvt_pk_bf16_f32 v39, v46, v47
    v_mul_f32_e32 v64, v64, v252
    v_mul_f32_e32 v65, v65, v252
    v_mul_f32_e32 v66, v66, v252
    v_mul_f32_e32 v67, v67, v252
    v_mul_f32_e32 v68, v68, v252
    v_mul_f32_e32 v69, v69, v252
    v_mul_f32_e32 v70, v70, v252
    v_mul_f32_e32 v71, v71, v252
    v_mul_f32_e32 v72, v72, v252
    v_mul_f32_e32 v73, v73, v252
    v_mul_f32_e32 v74, v74, v252
    v_mul_f32_e32 v75, v75, v252
    v_max3_f32 v250, v250, v76, v252
    v_cvt_pk_bf16_f32 v98, v64, v65
    v_cvt_pk_bf16_f32 v99, v66, v67
    v_cvt_pk_bf16_f32 v100, v68, v69
    v_cvt_pk_bf16_f32 v101, v70, v71
    v_cvt_pk_bf16_f32 v102, v72, v73
    v_cvt_pk_bf16_f32 v103, v74, v75
    v_mfma_f32_32x32x16_bf16 v[64:79], v[232:235], v[32:35], 0
    ds_read_b128 v[160:163], v254 offset:2048
    ds_read_b128 v[164:167], v254 offset:5120
    v_exp_f32_e32 v48, v48
    v_exp_f32_e32 v49, v49
    v_exp_f32_e32 v50, v50
    v_exp_f32_e32 v51, v51
    v_cvt_pk_bf16_f32 v48, v48, v49
    v_exp_f32_e32 v52, v52
    v_mfma_f32_32x32x16_bf16 v[64:79], v[236:239], v[36:39], v[64:79]
    ds_read_b128 v[168:171], v254 offset:8192
    ds_read_b128 v[172:175], v254 offset:11264
    v_exp_f32_e32 v53, v53
    v_cvt_pk_bf16_f32 v49, v50, v51
    v_exp_f32_e32 v54, v54
    v_exp_f32_e32 v55, v55
    v_cvt_pk_bf16_f32 v50, v52, v53
    v_exp_f32_e32 v56, v56
    v_exp_f32_e32 v57, v57
    v_cvt_pk_bf16_f32 v51, v54, v55
    v_exp_f32_e32 v58, v58
    v_exp_f32_e32 v59, v59
    v_cvt_pk_bf16_f32 v52, v56, v57
    v_exp_f32_e32 v60, v60
    v_exp_f32_e32 v61, v61
    v_cvt_pk_bf16_f32 v53, v58, v59
    v_exp_f32_e32 v62, v62
    v_exp_f32_e32 v63, v63
    v_cvt_pk_bf16_f32 v54, v60, v61
    v_cvt_pk_bf16_f32 v55, v62, v63
    v_mfma_f32_32x32x16_bf16 v[64:79], v[224:227], v[48:51], v[64:79]
    s_nop 0
    v_mfma_f32_32x32x16_bf16 v[64:79], v[228:231], v[52:55], v[64:79]
    ds_read_b128 v[32:35], v254 offset:7168
    ds_read_b128 v[36:39], v254 offset:10240
    ds_read_b128 v[40:43], v254 offset:13312
    ds_read_b128 v[44:47], v254 offset:16384
    s_nop 7
    v_rcp_f32_e32 v252, v76
    s_nop 0
    v_mul_f32_e32 v64, v64, v252
    v_mul_f32_e32 v65, v65, v252
    v_mul_f32_e32 v66, v66, v252
    v_mul_f32_e32 v67, v67, v252
    v_mul_f32_e32 v68, v68, v252
    v_mul_f32_e32 v69, v69, v252
    v_mul_f32_e32 v70, v70, v252
    v_mul_f32_e32 v71, v71, v252
    v_mul_f32_e32 v72, v72, v252
    v_mul_f32_e32 v73, v73, v252
    v_mul_f32_e32 v74, v74, v252
    v_mul_f32_e32 v75, v75, v252
    v_max3_f32 v250, v250, v76, v252
    v_cvt_pk_bf16_f32 v122, v64, v65
    v_cvt_pk_bf16_f32 v123, v66, v67
    v_cvt_pk_bf16_f32 v124, v68, v69
    v_cvt_pk_bf16_f32 v125, v70, v71
    v_cvt_pk_bf16_f32 v126, v72, v73
    v_cvt_pk_bf16_f32 v127, v74, v75
    v_cmp_ngt_f32 vcc, 0x4e800000, v250
    s_setprio 0
    s_cmp_eq_u32 s39, 63
    s_cbranch_scc1 L_ool3
L_oolr3:
    ds_read_b128 v[64:67], v254 offset:14336
    ds_read_b128 v[68:71], v254 offset:17408
    v_mfma_f32_32x32x16_bf16 v[128:143], v[0:3], v[80:83], 0
    s_cmp_lg_u64 vcc, 0
    s_cselect_b32 s74, 2, 0
    v_mfma_f32_32x32x16_bf16 v[128:143], v[4:7], v[84:87], v[128:143]
    s_or_b32 s63, s63, s74
    v_mfma_f32_32x32x16_bf16 v[128:143], v[8:11], v[88:91], v[128:143]
    v_mfma_f32_32x32x16_bf16 v[128:143], v[12:15], v[92:95], v[128:143]
    v_mfma_f32_32x32x16_bf16 v[128:143], v[16:19], v[96:99], v[128:143]
    v_mfma_f32_32x32x16_bf16 v[128:143], v[20:23], v[100:103], v[128:143]
    v_mfma_f32_32x32x16_bf16 v[144:159], v[24:27], v[80:83], 0
    s_nop 3
    v_mfma_f32_32x32x16_bf16 v[144:159], v[28:31], v[84:87], v[144:159]
    s_nop 3
    s_waitcnt lgkmcnt(5)
    v_mfma_f32_32x32x16_bf16 v[144:159], v[32:35], v[88:91], v[144:159]
    s_setprio 3
    v_cvt_pk_bf16_f32 v128, v128, v129
    v_cvt_pk_bf16_f32 v129, v130, v131
    v_cvt_pk_bf16_f32 v130, v132, v133
    v_cvt_pk_bf16_f32 v131, v134, v135
    s_setprio 0
    s_waitcnt lgkmcnt(4)
    v_mfma_f32_32x32x16_bf16 v[144:159], v[36:39], v[92:95], v[144:159]
    ds_write_b128 v243, v[128:131] offset:0
    s_setprio 3
    v_cvt_pk_bf16_f32 v132, v136, v137
    v_cvt_pk_bf16_f32 v133, v138, v139
    v_cvt_pk_bf16_f32 v134, v140, v141
    v_cvt_pk_bf16_f32 v135, v142, v143
    s_setprio 0
    s_waitcnt lgkmcnt(4)
    v_mfma_f32_32x32x16_bf16 v[144:159], v[40:43], v[96:99], v[144:159]
    ds_write_b128 v243, v[132:135] offset:32
    s_waitcnt lgkmcnt(4)
    v_mfma_f32_32x32x16_bf16 v[144:159], v[44:47], v[100:103], v[144:159]
    v_mfma_f32_32x32x16_bf16 v[48:63], v[160:163], v[80:83], 0
    s_nop 3
    v_mfma_f32_32x32x16_bf16 v[48:63], v[164:167], v[84:87], v[48:63]
    s_nop 3
    v_mfma_f32_32x32x16_bf16 v[48:63], v[168:171], v[88:91], v[48:63]
    s_setprio 3
    v_cvt_pk_bf16_f32 v144, v144, v145
    v_cvt_pk_bf16_f32 v145, v146, v147
    v_cvt_pk_bf16_f32 v146, v148, v149
    v_cvt_pk_bf16_f32 v147, v150, v151
    s_setprio 0
    v_mfma_f32_32x32x16_bf16 v[48:63], v[172:175], v[92:95], v[48:63]
    ds_write_b128 v243, v[144:147] offset:64
    s_setprio 3
    v_cvt_pk_bf16_f32 v148, v152, v153
    v_cvt_pk_bf16_f32 v149, v154, v155
    v_cvt_pk_bf16_f32 v150, v156, v157
    v_cvt_pk_bf16_f32 v151, v158, v159
    s_setprio 0
    s_waitcnt lgkmcnt(4)
    v_mfma_f32_32x32x16_bf16 v[48:63], v[64:67], v[96:99], v[48:63]
    ds_write_b128 v243, v[148:151] offset:96
    s_waitcnt lgkmcnt(4)
    v_mfma_f32_32x32x16_bf16 v[48:63], v[68:71], v[100:103], v[48:63]
    v_mfma_f32_32x32x16_bf16 v[128:143], v[0:3], v[104:107], 0
    s_nop 3
    v_mfma_f32_32x32x16_bf16 v[128:143], v[4:7], v[108:111], v[128:143]
    s_nop 3
    v_mfma_f32_32x32x16_bf16 v[128:143], v[8:11], v[112:115], v[128:143]
    s_setprio 3
    v_cvt_pk_bf16_f32 v48, v48, v49
    v_cvt_pk_bf16_f32 v49, v50, v51
    v_cvt_pk_bf16_f32 v50, v52, v53
    v_cvt_pk_bf16_f32 v51, v54, v55
    s_setprio 0
    v_mfma_f32_32x32x16_bf16 v[128:143], v[12:15], v[116:119], v[128:143]
    ds_write_b128 v245, v[48:51] offset:0
    s_setprio 3
    v_cvt_pk_bf16_f32 v52, v56, v57
    v_cvt_pk_bf16_f32 v53, v58, v59
    v_cvt_pk_bf16_f32 v54, v60, v61
    v_cvt_pk_bf16_f32 v55, v62, v63
    s_setprio 0
    v_mfma_f32_32x32x16_bf16 v[128:143], v[16:19], v[120:123], v[128:143]
    ds_write_b128 v246, v[52:55] offset:0
    ds_read_b128 v[80:83], v244 offset:0
    ds_read_b128 v[84:87], v244 offset:1024
    v_mfma_f32_32x32x16_bf16 v[128:143], v[20:23], v[124:127], v[128:143]
    ds_read_b128 v[88:91], v244 offset:2048
    ds_read_b128 v[92:95], v244 offset:3072
    ds_read_b128 v[96:99], v244 offset:4096
    v_mfma_f32_32x32x16_bf16 v[144:159], v[24:27], v[104:107], 0
    ds_read_b128 v[100:103], v244 offset:5120
    s_nop 2
    v_mfma_f32_32x32x16_bf16 v[144:159], v[28:31], v[108:111], v[144:159]
    s_waitcnt lgkmcnt(1)
    buffer_store_dwordx4 v[96:99], v248, s[20:23], s49 offen offset:0 sc0 sc1 nt
    s_nop 1
    v_mfma_f32_32x32x16_bf16 v[144:159], v[32:35], v[112:115], v[144:159]
    s_waitcnt lgkmcnt(0)
    buffer_store_dwordx4 v[100:103], v249, s[20:23], s49 offen offset:0 sc0 sc1 nt
    s_setprio 3
    v_cvt_pk_bf16_f32 v128, v128, v129
    v_cvt_pk_bf16_f32 v129, v130, v131
    v_cvt_pk_bf16_f32 v130, v132, v133
    v_cvt_pk_bf16_f32 v131, v134, v135
    s_setprio 0
    v_mfma_f32_32x32x16_bf16 v[144:159], v[36:39], v[116:119], v[144:159]
    buffer_store_dwordx4 v[80:83], v247, s[20:23], s48 offen offset:0 sc0 sc1 nt
    ds_write_b128 v243, v[128:131] offset:0
    s_setprio 3
    v_cvt_pk_bf16_f32 v132, v136, v137
    v_cvt_pk_bf16_f32 v133, v138, v139
    v_cvt_pk_bf16_f32 v134, v140, v141
    v_cvt_pk_bf16_f32 v135, v142, v143
    s_setprio 0
    v_mfma_f32_32x32x16_bf16 v[144:159], v[40:43], v[120:123], v[144:159]
    buffer_store_dwordx4 v[84:87], v248, s[20:23], s48 offen offset:0 sc0 sc1 nt
    ds_write_b128 v243, v[132:135] offset:32
    v_mfma_f32_32x32x16_bf16 v[144:159], v[44:47], v[124:127], v[144:159]
    buffer_store_dwordx4 v[88:91], v249, s[20:23], s48 offen offset:0 sc0 sc1 nt
    v_mfma_f32_32x32x16_bf16 v[48:63], v[160:163], v[104:107], 0
    buffer_store_dwordx4 v[92:95], v247, s[20:23], s49 offen offset:0 sc0 sc1 nt
    s_nop 2
    v_mfma_f32_32x32x16_bf16 v[48:63], v[164:167], v[108:111], v[48:63]
    s_nop 3
    v_mfma_f32_32x32x16_bf16 v[48:63], v[168:171], v[112:115], v[48:63]
    s_setprio 3
    v_cvt_pk_bf16_f32 v144, v144, v145
    v_cvt_pk_bf16_f32 v145, v146, v147
    v_cvt_pk_bf16_f32 v146, v148, v149
    v_cvt_pk_bf16_f32 v147, v150, v151
    s_setprio 0
    v_mfma_f32_32x32x16_bf16 v[48:63], v[172:175], v[116:119], v[48:63]
    ds_write_b128 v243, v[144:147] offset:64
    s_setprio 3
    v_cvt_pk_bf16_f32 v148, v152, v153
    v_cvt_pk_bf16_f32 v149, v154, v155
    v_cvt_pk_bf16_f32 v150, v156, v157
    v_cvt_pk_bf16_f32 v151, v158, v159
    s_setprio 0
    v_mfma_f32_32x32x16_bf16 v[48:63], v[64:67], v[120:123], v[48:63]
    ds_write_b128 v243, v[148:151] offset:96
    v_mfma_f32_32x32x16_bf16 v[48:63], v[68:71], v[124:127], v[48:63]
    s_setprio 3
    s_nop 10
    v_cvt_pk_bf16_f32 v48, v48, v49
    v_cvt_pk_bf16_f32 v49, v50, v51
    v_cvt_pk_bf16_f32 v50, v52, v53
    v_cvt_pk_bf16_f32 v51, v54, v55
    s_setprio 0
    ds_write_b128 v245, v[48:51] offset:0
    s_setprio 3
    v_cvt_pk_bf16_f32 v52, v56, v57
    v_cvt_pk_bf16_f32 v53, v58, v59
    v_cvt_pk_bf16_f32 v54, v60, v61
    v_cvt_pk_bf16_f32 v55, v62, v63
    s_setprio 0
    ds_write_b128 v246, v[52:55] offset:0
    ds_read_b128 v[104:107], v244 offset:0
    ds_read_b128 v[108:111], v244 offset:1024
    ds_read_b128 v[112:115], v244 offset:2048
    ds_read_b128 v[116:119], v244 offset:3072
    ds_read_b128 v[120:123], v244 offset:4096
    ds_read_b128 v[124:127], v244 offset:5120
    s_waitcnt lgkmcnt(5)
    buffer_store_dwordx4 v[104:107], v247, s[20:23], s50 offen offset:0 sc0 sc1 nt
    s_waitcnt lgkmcnt(4)
    buffer_store_dwordx4 v[108:111], v248, s[20:23], s50 offen offset:0 sc0 sc1 nt
    s_waitcnt lgkmcnt(3)
    buffer_store_dwordx4 v[112:115], v249, s[20:23], s50 offen offset:0 sc0 sc1 nt
    s_waitcnt lgkmcnt(2)
    buffer_store_dwordx4 v[116:119], v247, s[20:23], s51 offen offset:0 sc0 sc1 nt
    s_waitcnt lgkmcnt(1)
    buffer_store_dwordx4 v[120:123], v248, s[20:23], s51 offen offset:0 sc0 sc1 nt
    s_waitcnt lgkmcnt(0)
    buffer_store_dwordx4 v[124:127], v249, s[20:23], s51 offen offset:0 sc0 sc1 nt
    s_cmp_lg_u32 s63, 0
    s_cbranch_scc1 L_redo
L_fin:
L_end:
    s_endpgm
L_ool0:
    s_mov_b32 exec_lo, 0x0
    s_mov_b32 exec_hi, 0xffff0000
    v_add_u32 v247, 0xfffffd00, v247
    s_not_b64 exec, exec
    v_add_u32 v247, 0x17d00, v247
    s_mov_b32 exec_lo, 0xffffffff
    s_mov_b32 exec_hi, 0x0
    v_add_u32 v248, 0xfffffd00, v248
    s_not_b64 exec, exec
    v_add_u32 v248, 0x17d00, v248
    s_mov_b32 exec_lo, 0xffff0000
    s_mov_b32 exec_hi, 0xffffffff
    v_add_u32 v249, 0xfffffd00, v249
    s_not_b64 exec, exec
    v_add_u32 v249, 0x17d00, v249
    s_mov_b64 exec, -1
    s_branch L_oolr0
L_ool1:
    s_mov_b32 exec_lo, 0x0
    s_mov_b32 exec_hi, 0xffff0000
    v_add_u32 v247, 0x300, v247
    s_not_b64 exec, exec
    v_add_u32 v247, 0xfffe8300, v247
    s_mov_b32 exec_lo, 0xffffffff
    s_mov_b32 exec_hi, 0x0
    v_add_u32 v248, 0x300, v248
    s_not_b64 exec, exec
    v_add_u32 v248, 0xfffe8300, v248
    s_mov_b32 exec_lo, 0xffff0000
    s_mov_b32 exec_hi, 0xffffffff
    v_add_u32 v249, 0x300, v249
    s_not_b64 exec, exec
    v_add_u32 v249, 0xfffe8300, v249
    s_mov_b64 exec, -1
    s_branch L_oolr1
L_ool2:
    s_mov_b32 exec_lo, 0xf0f0f0f0
    s_mov_b32 exec_hi, 0x0f0f0f0f
    v_add_u32 v241, 11520, v241
    v_mov_b32 v242, v241
    s_mov_b64 exec, -1
    s_branch L_oolr2
L_ool3:
    s_mov_b32 exec_lo, 0x0
    s_mov_b32 exec_hi, 0xffff0000
    v_add_u32 v247, 0xfffffd00, v247
    s_not_b64 exec, exec
    v_add_u32 v247, 0x17d00, v247
    s_mov_b32 exec_lo, 0xffffffff
    s_mov_b32 exec_hi, 0x0
    v_add_u32 v248, 0xfffffd00, v248
    s_not_b64 exec, exec
    v_add_u32 v248, 0x17d00, v248
    s_mov_b32 exec_lo, 0xffff0000
    s_mov_b32 exec_hi, 0xffffffff
    v_add_u32 v249, 0xfffffd00, v249
    s_not_b64 exec, exec
    v_add_u32 v249, 0x17d00, v249
    s_mov_b64 exec, -1
    s_branch L_oolr3
L_redo:
    s_waitcnt vmcnt(0) lgkmcnt(0)
    s_nop 15
    s_ff1_i32_b32 s64, s63
    s_lshl_b32 s72, 1, s64
    s_andn2_b32 s63, s63, s72
    s_cmp_eq_u32 s64, 0
    s_cselect_b32 s67, s38, s39
    s_mul_i32 s72, s67, 1536
    s_add_u32 s72, s72, 768
    s_cmp_eq_u32 s67, 63
    s_cselect_b32 s72, 0, s72
    s_add_u32 s44, s65, s72
    s_add_u32 s45, s44, 196608
    s_add_u32 s46, s66, s72
    s_add_u32 s47, s46, 196608
    s_mov_b32 s73, 96768
    v_add_u32 v252, 0, v253
    v_mul_u32_u24 v254, 43691, v252
    v_lshrrev_b32 v254, 19, v254
    v_lshrrev_b32 v250, 2, v254
    v_sub_u32 v250, v250, v254
    v_and_b32 v250, 3, v250
    v_sub_u32 v247, v252, v250
    v_mul_u32_u24 v250, 12, v254
    v_cmp_lt_i32 vcc, v247, v250
    v_add_u32 v252, 12, v247
    v_lshrrev_b32 v254, 3, v254
    v_cndmask_b32 v247, v247, v252, vcc
    v_lshlrev_b32 v247, 4, v247
    v_mad_u32_u24 v247, v254, s73, v247
    v_add_u32 v252, 64, v253
    v_mul_u32_u24 v254, 43691, v252
    v_lshrrev_b32 v254, 19, v254
    v_lshrrev_b32 v250, 2, v254
    v_sub_u32 v250, v250, v254
    v_and_b32 v250, 3, v250
    v_sub_u32 v248, v252, v250
    v_mul_u32_u24 v250, 12, v254
    v_cmp_lt_i32 vcc, v248, v250
    v_add_u32 v252, 12, v248
    v_lshrrev_b32 v254, 3, v254
    v_cndmask_b32 v248, v248, v252, vcc
    v_lshlrev_b32 v248, 4, v248
    v_mad_u32_u24 v248, v254, s73, v248
    v_add_u32 v252, 128, v253
    v_mul_u32_u24 v254, 43691, v252
    v_lshrrev_b32 v254, 19, v254
    v_lshrrev_b32 v250, 2, v254
    v_sub_u32 v250, v250, v254
    v_and_b32 v250, 3, v250
    v_sub_u32 v249, v252, v250
    v_mul_u32_u24 v250, 12, v254
    v_cmp_lt_i32 vcc, v249, v250
    v_add_u32 v252, 12, v249
    v_lshrrev_b32 v254, 3, v254
    v_cndmask_b32 v249, v249, v252, vcc
    v_lshlrev_b32 v249, 4, v249
    v_mad_u32_u24 v249, v254, s73, v249
    v_bfe_u32 v252, v253, 3, 2
    v_mul_u32_u24 v252, 24, v252
    v_and_b32 v250, 7, v253
    v_add_u32 v252, v252, v250
    v_lshrrev_b32 v254, 5, v253
    v_lshlrev_b32 v254, 2, v254
    v_sub_u32 v252, v252, v254
    v_lshlrev_b32 v252, 4, v252
    v_add_u32 v241, 73792, v252
    v_add_u32 v242, s62, v241
    s_cmp_eq_u32 s67, 63
    s_cbranch_scc1 L_ool4
L_oolr4:
    buffer_load_dwordx4 v[0:3], v247, s[16:19], s44 offen offset:0 nt
    buffer_load_dwordx4 v[4:7], v248, s[16:19], s44 offen offset:0 nt
    buffer_load_dwordx4 v[8:11], v249, s[16:19], s44 offen offset:0 nt
    buffer_load_dwordx4 v[12:15], v247, s[16:19], s45 offen offset:0 nt
    buffer_load_dwordx4 v[16:19], v248, s[16:19], s45 offen offset:0 nt
    buffer_load_dwordx4 v[20:23], v249, s[16:19], s45 offen offset:0 nt
    buffer_load_dwordx4 v[24:27], v247, s[16:19], s46 offen offset:0 nt
    buffer_load_dwordx4 v[28:31], v248, s[16:19], s46 offen offset:0 nt
    buffer_load_dwordx4 v[32:35], v249, s[16:19], s46 offen offset:0 nt
    buffer_load_dwordx4 v[36:39], v247, s[16:19], s47 offen offset:0 nt
    buffer_load_dwordx4 v[40:43], v248, s[16:19], s47 offen offset:0 nt
    buffer_load_dwordx4 v[44:47], v249, s[16:19], s47 offen offset:0 nt
    s_waitcnt vmcnt(11)
    ds_write_b128 v244, v[0:3] offset:0
    s_waitcnt vmcnt(10)
    ds_write_b128 v244, v[4:7] offset:1024
    s_waitcnt vmcnt(9)
    ds_write_b128 v244, v[8:11] offset:2048
    s_waitcnt vmcnt(8)
    ds_write_b128 v244, v[12:15] offset:3072
    s_waitcnt vmcnt(7)
    ds_write_b128 v244, v[16:19] offset:4096
    s_waitcnt vmcnt(6)
    ds_write_b128 v244, v[20:23] offset:5120
    ds_read_b128 v[0:3], v243 offset:0
    ds_read_b128 v[4:7], v243 offset:32
    ds_read_b128 v[8:11], v243 offset:64
    ds_read_b128 v[12:15], v243 offset:96
    ds_read_b128 v[16:19], v245 offset:0
    ds_read_b128 v[20:23], v246 offset:0
    s_waitcnt vmcnt(5)
    ds_write_b128 v244, v[24:27] offset:0
    s_waitcnt vmcnt(4)
    ds_write_b128 v244, v[28:31] offset:1024
    s_waitcnt vmcnt(3)
    ds_write_b128 v244, v[32:35] offset:2048
    s_waitcnt vmcnt(2)
    s_waitcnt lgkmcnt(13)
    ds_write_b128 v244, v[36:39] offset:3072
    s_waitcnt vmcnt(1)
    ds_write_b128 v244, v[40:43] offset:4096
    s_waitcnt vmcnt(0)
    s_waitcnt lgkmcnt(13)
    ds_write_b128 v244, v[44:47] offset:5120
    ds_read_b128 v[24:27], v243 offset:0
    s_waitcnt lgkmcnt(13)
    ds_read_b128 v[28:31], v243 offset:32
    ds_read_b128 v[32:35], v243 offset:64
    s_waitcnt lgkmcnt(13)
    ds_read_b128 v[36:39], v243 offset:96
    ds_read_b128 v[40:43], v245 offset:0
    s_waitcnt lgkmcnt(13)
    ds_read_b128 v[44:47], v246 offset:0
    ds_read_b128 v[96:99], v240 offset:6144
    s_waitcnt lgkmcnt(13)
    ds_read_b128 v[100:103], v240 offset:15360
    ds_read_b128 v[120:123], v240 offset:24576
    s_waitcnt lgkmcnt(2)
    v_mfma_f32_32x32x16_bf16 v[80:95], v[0:3], v[96:99], 0
    ds_read_b128 v[124:127], v240 offset:33792
    v_mfma_f32_32x32x16_bf16 v[104:119], v[24:27], v[96:99], 0
    s_waitcnt lgkmcnt(2)
    v_mfma_f32_32x32x16_bf16 v[80:95], v[4:7], v[100:103], v[80:95]
    ds_read_b128 v[96:99], v240 offset:43008
    v_mfma_f32_32x32x16_bf16 v[104:119], v[28:31], v[100:103], v[104:119]
    s_waitcnt lgkmcnt(2)
    v_mfma_f32_32x32x16_bf16 v[80:95], v[8:11], v[120:123], v[80:95]
    ds_read_b128 v[100:103], v240 offset:52224
    v_mfma_f32_32x32x16_bf16 v[104:119], v[32:35], v[120:123], v[104:119]
    s_waitcnt lgkmcnt(2)
    v_mfma_f32_32x32x16_bf16 v[80:95], v[12:15], v[124:127], v[80:95]
    ds_read_b128 v[120:123], v240 offset:7168
    v_mfma_f32_32x32x16_bf16 v[104:119], v[36:39], v[124:127], v[104:119]
    s_waitcnt lgkmcnt(2)
    v_mfma_f32_32x32x16_bf16 v[80:95], v[16:19], v[96:99], v[80:95]
    ds_read_b128 v[124:127], v240 offset:16384
    v_mfma_f32_32x32x16_bf16 v[104:119], v[40:43], v[96:99], v[104:119]
    s_waitcnt lgkmcnt(2)
    v_mfma_f32_32x32x16_bf16 v[80:95], v[20:23], v[100:103], v[80:95]
    ds_read_b128 v[96:99], v240 offset:25600
    v_mfma_f32_32x32x16_bf16 v[104:119], v[44:47], v[100:103], v[104:119]
    s_waitcnt lgkmcnt(2)
    v_mfma_f32_32x32x16_bf16 v[48:63], v[0:3], v[120:123], 0
    ds_read_b128 v[100:103], v240 offset:34816
    v_mfma_f32_32x32x16_bf16 v[64:79], v[24:27], v[120:123], 0
    s_waitcnt lgkmcnt(2)
    v_mfma_f32_32x32x16_bf16 v[48:63], v[4:7], v[124:127], v[48:63]
    ds_read_b128 v[120:123], v240 offset:44032
    s_setprio 3
    s_mov_b64 exec, s[52:53]
    s_nop 0
    v_cvt_pk_bf16_f32 v224, v80, v81
    v_cvt_pk_bf16_f32 v225, v82, v83
    s_not_b64 exec, exec
    v_cvt_pk_bf16_f32 v176, v80, v81
    v_cvt_pk_bf16_f32 v177, v82, v83
    s_mov_b64 exec, -1
    s_setprio 0
    v_mfma_f32_32x32x16_bf16 v[64:79], v[28:31], v[124:127], v[64:79]
    s_setprio 3
    s_mov_b64 exec, s[52:53]
    v_cvt_pk_bf16_f32 v226, v84, v85
    v_cvt_pk_bf16_f32 v227, v86, v87
    s_not_b64 exec, exec
    v_cvt_pk_bf16_f32 v178, v84, v85
    v_cvt_pk_bf16_f32 v179, v86, v87
    s_mov_b64 exec, -1
    s_setprio 0
    s_waitcnt lgkmcnt(2)
    v_mfma_f32_32x32x16_bf16 v[48:63], v[8:11], v[96:99], v[48:63]
    ds_read_b128 v[124:127], v240 offset:53248
    s_setprio 3
    s_mov_b64 exec, s[52:53]
    v_cvt_pk_bf16_f32 v228, v88, v89
    v_cvt_pk_bf16_f32 v229, v90, v91
    s_not_b64 exec, exec
    v_cvt_pk_bf16_f32 v180, v88, v89
    v_cvt_pk_bf16_f32 v181, v90, v91
    s_mov_b64 exec, -1
    s_setprio 0
    v_mfma_f32_32x32x16_bf16 v[64:79], v[32:35], v[96:99], v[64:79]
    s_setprio 3
    s_mov_b64 exec, s[52:53]
    v_cvt_pk_bf16_f32 v230, v92, v93
    v_cvt_pk_bf16_f32 v231, v94, v95
    s_not_b64 exec, exec
    v_cvt_pk_bf16_f32 v182, v92, v93
    v_cvt_pk_bf16_f32 v183, v94, v95
    s_mov_b64 exec, -1
    s_setprio 0
    s_waitcnt lgkmcnt(2)
    v_mfma_f32_32x32x16_bf16 v[48:63], v[12:15], v[100:103], v[48:63]
    ds_read_b128 v[96:99], v240 offset:8192
    s_setprio 3
    s_mov_b64 exec, s[52:53]
    v_cvt_pk_bf16_f32 v232, v104, v105
    v_cvt_pk_bf16_f32 v233, v106, v107
    s_not_b64 exec, exec
    v_cvt_pk_bf16_f32 v184, v104, v105
    v_cvt_pk_bf16_f32 v185, v106, v107
    s_mov_b64 exec, -1
    s_setprio 0
    v_mfma_f32_32x32x16_bf16 v[64:79], v[36:39], v[100:103], v[64:79]
    s_setprio 3
    s_mov_b64 exec, s[52:53]
    v_cvt_pk_bf16_f32 v234, v108, v109
    v_cvt_pk_bf16_f32 v235, v110, v111
    s_not_b64 exec, exec
    v_cvt_pk_bf16_f32 v186, v108, v109
    v_cvt_pk_bf16_f32 v187, v110, v111
    s_mov_b64 exec, -1
    s_setprio 0
    s_waitcnt lgkmcnt(2)
    v_mfma_f32_32x32x16_bf16 v[48:63], v[16:19], v[120:123], v[48:63]
    ds_read_b128 v[100:103], v240 offset:17408
    s_setprio 3
    s_mov_b64 exec, s[52:53]
    v_cvt_pk_bf16_f32 v236, v112, v113
    v_cvt_pk_bf16_f32 v237, v114, v115
    s_not_b64 exec, exec
    v_cvt_pk_bf16_f32 v188, v112, v113
    v_cvt_pk_bf16_f32 v189, v114, v115
    s_mov_b64 exec, -1
    s_setprio 0
    v_mfma_f32_32x32x16_bf16 v[64:79], v[40:43], v[120:123], v[64:79]
    s_setprio 3
    s_mov_b64 exec, s[52:53]
    v_cvt_pk_bf16_f32 v238, v116, v117
    v_cvt_pk_bf16_f32 v239, v118, v119
    s_not_b64 exec, exec
    v_cvt_pk_bf16_f32 v190, v116, v117
    v_cvt_pk_bf16_f32 v191, v118, v119
    s_mov_b64 exec, -1
    s_setprio 0
    s_waitcnt lgkmcnt(2)
    v_mfma_f32_32x32x16_bf16 v[48:63], v[20:23], v[124:127], v[48:63]
    ds_read_b128 v[120:123], v240 offset:26624
    v_mfma_f32_32x32x16_bf16 v[64:79], v[44:47], v[124:127], v[64:79]
    s_waitcnt lgkmcnt(2)
    v_mfma_f32_32x32x16_bf16 v[80:95], v[0:3], v[96:99], 0
    ds_read_b128 v[124:127], v240 offset:35840
    v_mfma_f32_32x32x16_bf16 v[104:119], v[24:27], v[96:99], 0
    s_waitcnt lgkmcnt(2)
    v_mfma_f32_32x32x16_bf16 v[80:95], v[4:7], v[100:103], v[80:95]
    ds_read_b128 v[96:99], v240 offset:45056
    s_setprio 3
    s_mov_b64 exec, s[54:55]
    s_nop 0
    v_cvt_pk_bf16_f32 v224, v48, v49
    v_cvt_pk_bf16_f32 v225, v50, v51
    s_not_b64 exec, exec
    v_cvt_pk_bf16_f32 v192, v48, v49
    v_cvt_pk_bf16_f32 v193, v50, v51
    s_mov_b64 exec, -1
    s_setprio 0
    v_mfma_f32_32x32x16_bf16 v[104:119], v[28:31], v[100:103], v[104:119]
    s_setprio 3
    s_mov_b64 exec, s[54:55]
    v_cvt_pk_bf16_f32 v226, v52, v53
    v_cvt_pk_bf16_f32 v227, v54, v55
    s_not_b64 exec, exec
    v_cvt_pk_bf16_f32 v194, v52, v53
    v_cvt_pk_bf16_f32 v195, v54, v55
    s_mov_b64 exec, -1
    s_setprio 0
    s_waitcnt lgkmcnt(2)
    v_mfma_f32_32x32x16_bf16 v[80:95], v[8:11], v[120:123], v[80:95]
    ds_read_b128 v[100:103], v240 offset:54272
    s_setprio 3
    s_mov_b64 exec, s[54:55]
    v_cvt_pk_bf16_f32 v228, v56, v57
    v_cvt_pk_bf16_f32 v229, v58, v59
    s_not_b64 exec, exec
    v_cvt_pk_bf16_f32 v196, v56, v57
    v_cvt_pk_bf16_f32 v197, v58, v59
    s_mov_b64 exec, -1
    s_setprio 0
    v_mfma_f32_32x32x16_bf16 v[104:119], v[32:35], v[120:123], v[104:119]
    s_setprio 3
    s_mov_b64 exec, s[54:55]
    v_cvt_pk_bf16_f32 v230, v60, v61
    v_cvt_pk_bf16_f32 v231, v62, v63
    s_not_b64 exec, exec
    v_cvt_pk_bf16_f32 v198, v60, v61
    v_cvt_pk_bf16_f32 v199, v62, v63
    s_mov_b64 exec, -1
    s_setprio 0
    s_waitcnt lgkmcnt(2)
    v_mfma_f32_32x32x16_bf16 v[80:95], v[12:15], v[124:127], v[80:95]
    ds_read_b128 v[120:123], v240 offset:3072
    s_setprio 3
    s_mov_b64 exec, s[54:55]
    v_cvt_pk_bf16_f32 v232, v64, v65
    v_cvt_pk_bf16_f32 v233, v66, v67
    s_not_b64 exec, exec
    v_cvt_pk_bf16_f32 v200, v64, v65
    v_cvt_pk_bf16_f32 v201, v66, v67
    s_mov_b64 exec, -1
    s_setprio 0
    v_mfma_f32_32x32x16_bf16 v[104:119], v[36:39], v[124:127], v[104:119]
    s_setprio 3
    s_mov_b64 exec, s[54:55]
    v_cvt_pk_bf16_f32 v234, v68, v69
    v_cvt_pk_bf16_f32 v235, v70, v71
    s_not_b64 exec, exec
    v_cvt_pk_bf16_f32 v202, v68, v69
    v_cvt_pk_bf16_f32 v203, v70, v71
    s_mov_b64 exec, -1
    s_setprio 0
    s_waitcnt lgkmcnt(2)
    v_mfma_f32_32x32x16_bf16 v[80:95], v[16:19], v[96:99], v[80:95]
    ds_read_b128 v[124:127], v240 offset:12288
    s_setprio 3
    s_mov_b64 exec, s[54:55]
    v_cvt_pk_bf16_f32 v236, v72, v73
    v_cvt_pk_bf16_f32 v237, v74, v75
    s_not_b64 exec, exec
    v_cvt_pk_bf16_f32 v204, v72, v73
    v_cvt_pk_bf16_f32 v205, v74, v75
    s_mov_b64 exec, -1
    s_setprio 0
    v_mfma_f32_32x32x16_bf16 v[104:119], v[40:43], v[96:99], v[104:119]
    s_setprio 3
    s_mov_b64 exec, s[54:55]
    v_cvt_pk_bf16_f32 v238, v76, v77
    v_cvt_pk_bf16_f32 v239, v78, v79
    s_not_b64 exec, exec
    v_cvt_pk_bf16_f32 v206, v76, v77
    v_cvt_pk_bf16_f32 v207, v78, v79
    s_mov_b64 exec, -1
    s_setprio 0
    s_waitcnt lgkmcnt(2)
    v_mfma_f32_32x32x16_bf16 v[80:95], v[20:23], v[100:103], v[80:95]
    ds_read_b128 v[96:99], v240 offset:21504
    v_mfma_f32_32x32x16_bf16 v[104:119], v[44:47], v[100:103], v[104:119]
    s_setprio 1
    s_waitcnt lgkmcnt(2)
    v_mfma_f32_32x32x16_bf16 v[48:63], v[120:123], v[0:3], 0
    ds_read_b128 v[100:103], v240 offset:30720
    v_mfma_f32_32x32x16_bf16 v[64:79], v[120:123], v[24:27], 0
    s_waitcnt lgkmcnt(2)
    v_mfma_f32_32x32x16_bf16 v[48:63], v[124:127], v[4:7], v[48:63]
    ds_read_b128 v[120:123], v240 offset:39936
    s_setprio 3
    s_mov_b64 exec, s[56:57]
    v_cvt_pk_bf16_f32 v224, v80, v81
    v_cvt_pk_bf16_f32 v225, v82, v83
    s_not_b64 exec, exec
    v_cvt_pk_bf16_f32 v208, v80, v81
    v_cvt_pk_bf16_f32 v209, v82, v83
    s_mov_b64 exec, -1
    s_setprio 1
    v_mfma_f32_32x32x16_bf16 v[64:79], v[124:127], v[28:31], v[64:79]
    s_setprio 3
    s_mov_b64 exec, s[56:57]
    v_cvt_pk_bf16_f32 v226, v84, v85
    v_cvt_pk_bf16_f32 v227, v86, v87
    s_not_b64 exec, exec
    v_cvt_pk_bf16_f32 v210, v84, v85
    v_cvt_pk_bf16_f32 v211, v86, v87
    s_mov_b64 exec, -1
    s_setprio 1
    s_waitcnt lgkmcnt(2)
    v_mfma_f32_32x32x16_bf16 v[48:63], v[96:99], v[8:11], v[48:63]
    ds_read_b128 v[124:127], v240 offset:49152
    s_setprio 3
    s_mov_b64 exec, s[56:57]
    v_cvt_pk_bf16_f32 v228, v88, v89
    v_cvt_pk_bf16_f32 v229, v90, v91
    s_not_b64 exec, exec
    v_cvt_pk_bf16_f32 v212, v88, v89
    v_cvt_pk_bf16_f32 v213, v90, v91
    s_mov_b64 exec, -1
    s_setprio 1
    v_mfma_f32_32x32x16_bf16 v[64:79], v[96:99], v[32:35], v[64:79]
    s_setprio 3
    s_mov_b64 exec, s[56:57]
    v_cvt_pk_bf16_f32 v230, v92, v93
    v_cvt_pk_bf16_f32 v231, v94, v95
    s_not_b64 exec, exec
    v_cvt_pk_bf16_f32 v214, v92, v93
    v_cvt_pk_bf16_f32 v215, v94, v95
    s_mov_b64 exec, -1
    s_setprio 1
    s_waitcnt lgkmcnt(2)
    v_mfma_f32_32x32x16_bf16 v[48:63], v[100:103], v[12:15], v[48:63]
    ds_read_b128 v[96:99], v240 offset:4096
    s_setprio 3
    s_mov_b64 exec, s[56:57]
    v_cvt_pk_bf16_f32 v232, v104, v105
    v_cvt_pk_bf16_f32 v233, v106, v107
    s_not_b64 exec, exec
    v_cvt_pk_bf16_f32 v216, v104, v105
    v_cvt_pk_bf16_f32 v217, v106, v107
    s_mov_b64 exec, -1
    s_setprio 1
    v_mfma_f32_32x32x16_bf16 v[64:79], v[100:103], v[36:39], v[64:79]
    s_setprio 3
    s_mov_b64 exec, s[56:57]
    v_cvt_pk_bf16_f32 v234, v108, v109
    v_cvt_pk_bf16_f32 v235, v110, v111
    s_not_b64 exec, exec
    v_cvt_pk_bf16_f32 v218, v108, v109
    v_cvt_pk_bf16_f32 v219, v110, v111
    s_mov_b64 exec, -1
    s_setprio 1
    s_waitcnt lgkmcnt(2)
    v_mfma_f32_32x32x16_bf16 v[48:63], v[120:123], v[16:19], v[48:63]
    ds_read_b128 v[100:103], v240 offset:13312
    s_setprio 3
    s_mov_b64 exec, s[56:57]
    v_cvt_pk_bf16_f32 v236, v112, v113
    v_cvt_pk_bf16_f32 v237, v114, v115
    s_not_b64 exec, exec
    v_cvt_pk_bf16_f32 v220, v112, v113
    v_cvt_pk_bf16_f32 v221, v114, v115
    s_mov_b64 exec, -1
    s_setprio 1
    v_mfma_f32_32x32x16_bf16 v[64:79], v[120:123], v[40:43], v[64:79]
    s_setprio 3
    s_mov_b64 exec, s[56:57]
    v_cvt_pk_bf16_f32 v238, v116, v117
    v_cvt_pk_bf16_f32 v239, v118, v119
    s_not_b64 exec, exec
    v_cvt_pk_bf16_f32 v222, v116, v117
    v_cvt_pk_bf16_f32 v223, v118, v119
    s_mov_b64 exec, -1
    s_setprio 1
    s_waitcnt lgkmcnt(2)
    v_mfma_f32_32x32x16_bf16 v[48:63], v[124:127], v[20:23], v[48:63]
    ds_read_b128 v[120:123], v240 offset:22528
    v_mfma_f32_32x32x16_bf16 v[64:79], v[124:127], v[44:47], v[64:79]
    s_waitcnt lgkmcnt(2)
    v_mfma_f32_32x32x16_bf16 v[80:95], v[96:99], v[0:3], 0
    ds_read_b128 v[124:127], v240 offset:31744
    v_mfma_f32_32x32x16_bf16 v[104:119], v[96:99], v[24:27], 0
    s_waitcnt lgkmcnt(2)
    v_mfma_f32_32x32x16_bf16 v[80:95], v[100:103], v[4:7], v[80:95]
    ds_read_b128 v[96:99], v240 offset:40960
    v_mfma_f32_32x32x16_bf16 v[104:119], v[100:103], v[28:31], v[104:119]
    s_setprio 3
    s_nop 0
    v_cvt_pk_bf16_f32 v134, v48, v49
    v_cvt_pk_bf16_f32 v135, v50, v51
    v_cvt_pk_bf16_f32 v136, v52, v53
    v_cvt_pk_bf16_f32 v137, v54, v55
    s_setprio 1
    s_waitcnt lgkmcnt(2)
    v_mfma_f32_32x32x16_bf16 v[80:95], v[120:123], v[8:11], v[80:95]
    ds_read_b128 v[100:103], v240 offset:50176
    v_mfma_f32_32x32x16_bf16 v[104:119], v[120:123], v[32:35], v[104:119]
    s_setprio 3
    v_cvt_pk_bf16_f32 v138, v56, v57
    v_cvt_pk_bf16_f32 v139, v58, v59
    v_cvt_pk_bf16_f32 v146, v60, v61
    v_cvt_pk_bf16_f32 v147, v62, v63
    s_setprio 1
    s_waitcnt lgkmcnt(2)
    v_mfma_f32_32x32x16_bf16 v[80:95], v[124:127], v[12:15], v[80:95]
    ds_read_b128 v[120:123], v240 offset:5120
    v_mfma_f32_32x32x16_bf16 v[104:119], v[124:127], v[36:39], v[104:119]
    s_setprio 3
    v_cvt_pk_bf16_f32 v128, v64, v65
    v_cvt_pk_bf16_f32 v129, v66, v67
    v_cvt_pk_bf16_f32 v130, v68, v69
    v_cvt_pk_bf16_f32 v131, v70, v71
    s_setprio 1
    s_waitcnt lgkmcnt(2)
    v_mfma_f32_32x32x16_bf16 v[80:95], v[96:99], v[16:19], v[80:95]
    ds_read_b128 v[124:127], v240 offset:14336
    v_mfma_f32_32x32x16_bf16 v[104:119], v[96:99], v[40:43], v[104:119]
    s_setprio 3
    v_cvt_pk_bf16_f32 v132, v72, v73
    v_cvt_pk_bf16_f32 v133, v74, v75
    v_cvt_pk_bf16_f32 v140, v76, v77
    v_cvt_pk_bf16_f32 v141, v78, v79
    s_setprio 1
    s_waitcnt lgkmcnt(2)
    v_mfma_f32_32x32x16_bf16 v[80:95], v[100:103], v[20:23], v[80:95]
    ds_read_b128 v[96:99], v240 offset:23552
    v_mfma_f32_32x32x16_bf16 v[104:119], v[100:103], v[44:47], v[104:119]
    s_waitcnt lgkmcnt(2)
    v_mfma_f32_32x32x16_bf16 v[48:63], v[120:123], v[0:3], 0
    ds_read_b128 v[100:103], v240 offset:32768
    v_mfma_f32_32x32x16_bf16 v[64:79], v[120:123], v[24:27], 0
    s_waitcnt lgkmcnt(2)
    v_mfma_f32_32x32x16_bf16 v[48:63], v[124:127], v[4:7], v[48:63]
    ds_read_b128 v[120:123], v240 offset:41984
    v_mfma_f32_32x32x16_bf16 v[64:79], v[124:127], v[28:31], v[64:79]
    s_setprio 3
    s_nop 0
    v_cvt_pk_bf16_f32 v148, v80, v81
    v_cvt_pk_bf16_f32 v149, v82, v83
    v_cvt_pk_bf16_f32 v150, v84, v85
    v_cvt_pk_bf16_f32 v151, v86, v87
    s_setprio 1
    s_waitcnt lgkmcnt(2)
    v_mfma_f32_32x32x16_bf16 v[48:63], v[96:99], v[8:11], v[48:63]
    ds_read_b128 v[124:127], v240 offset:51200
    v_mfma_f32_32x32x16_bf16 v[64:79], v[96:99], v[32:35], v[64:79]
    s_setprio 3
    v_cvt_pk_bf16_f32 v158, v88, v89
    v_cvt_pk_bf16_f32 v159, v90, v91
    v_cvt_pk_bf16_f32 v160, v92, v93
    v_cvt_pk_bf16_f32 v161, v94, v95
    s_setprio 1
    s_waitcnt lgkmcnt(2)
    v_mfma_f32_32x32x16_bf16 v[48:63], v[100:103], v[12:15], v[48:63]
    ds_read_b128 v[96:99], v240 offset:0
    v_mfma_f32_32x32x16_bf16 v[64:79], v[100:103], v[36:39], v[64:79]
    s_setprio 3
    v_cvt_pk_bf16_f32 v142, v104, v105
    v_cvt_pk_bf16_f32 v143, v106, v107
    v_cvt_pk_bf16_f32 v144, v108, v109
    v_cvt_pk_bf16_f32 v145, v110, v111
    s_setprio 1
    s_waitcnt lgkmcnt(2)
    v_mfma_f32_32x32x16_bf16 v[48:63], v[120:123], v[16:19], v[48:63]
    ds_read_b128 v[100:103], v240 offset:9216
    v_mfma_f32_32x32x16_bf16 v[64:79], v[120:123], v[40:43], v[64:79]
    s_setprio 3
    v_cvt_pk_bf16_f32 v152, v112, v113
    v_cvt_pk_bf16_f32 v153, v114, v115
    v_cvt_pk_bf16_f32 v154, v116, v117
    v_cvt_pk_bf16_f32 v155, v118, v119
    s_setprio 1
    s_waitcnt lgkmcnt(2)
    v_mfma_f32_32x32x16_bf16 v[48:63], v[124:127], v[20:23], v[48:63]
    ds_read_b128 v[120:123], v240 offset:18432
    v_mfma_f32_32x32x16_bf16 v[64:79], v[124:127], v[44:47], v[64:79]
    s_waitcnt lgkmcnt(2)
    v_mfma_f32_32x32x16_bf16 v[80:95], v[96:99], v[0:3], 0
    ds_read_b128 v[124:127], v240 offset:27648
    v_mfma_f32_32x32x16_bf16 v[104:119], v[96:99], v[24:27], 0
    s_waitcnt lgkmcnt(2)
    v_mfma_f32_32x32x16_bf16 v[80:95], v[100:103], v[4:7], v[80:95]
    ds_read_b128 v[96:99], v240 offset:36864
    v_mfma_f32_32x32x16_bf16 v[104:119], v[100:103], v[28:31], v[104:119]
    s_setprio 3
    s_nop 0
    v_cvt_pk_bf16_f32 v162, v48, v49
    v_cvt_pk_bf16_f32 v163, v50, v51
    v_cvt_pk_bf16_f32 v170, v52, v53
    v_cvt_pk_bf16_f32 v171, v54, v55
    s_setprio 1
    s_waitcnt lgkmcnt(2)
    v_mfma_f32_32x32x16_bf16 v[80:95], v[120:123], v[8:11], v[80:95]
    ds_read_b128 v[100:103], v240 offset:46080
    v_mfma_f32_32x32x16_bf16 v[104:119], v[120:123], v[32:35], v[104:119]
    s_setprio 3
    v_cvt_pk_bf16_f32 v172, v56, v57
    v_cvt_pk_bf16_f32 v173, v58, v59
    v_cvt_pk_bf16_f32 v174, v60, v61
    v_cvt_pk_bf16_f32 v175, v62, v63
    s_setprio 1
    s_waitcnt lgkmcnt(2)
    v_mfma_f32_32x32x16_bf16 v[80:95], v[124:127], v[12:15], v[80:95]
    ds_read_b128 v[120:123], v240 offset:1024
    v_mfma_f32_32x32x16_bf16 v[104:119], v[124:127], v[36:39], v[104:119]
    s_setprio 3
    v_cvt_pk_bf16_f32 v156, v64, v65
    v_cvt_pk_bf16_f32 v157, v66, v67
    v_cvt_pk_bf16_f32 v164, v68, v69
    v_cvt_pk_bf16_f32 v165, v70, v71
    s_setprio 1
    s_waitcnt lgkmcnt(2)
    v_mfma_f32_32x32x16_bf16 v[80:95], v[96:99], v[16:19], v[80:95]
    ds_read_b128 v[124:127], v240 offset:10240
    v_mfma_f32_32x32x16_bf16 v[104:119], v[96:99], v[40:43], v[104:119]
    s_setprio 3
    v_cvt_pk_bf16_f32 v166, v72, v73
    v_cvt_pk_bf16_f32 v167, v74, v75
    v_cvt_pk_bf16_f32 v168, v76, v77
    v_cvt_pk_bf16_f32 v169, v78, v79
    s_setprio 1
    s_waitcnt lgkmcnt(2)
    v_mfma_f32_32x32x16_bf16 v[80:95], v[100:103], v[20:23], v[80:95]
    ds_read_b128 v[96:99], v240 offset:19456
    v_mfma_f32_32x32x16_bf16 v[104:119], v[100:103], v[44:47], v[104:119]
    s_waitcnt lgkmcnt(2)
    v_mfma_f32_32x32x16_bf16 v[48:63], v[120:123], v[0:3], 0
    ds_read_b128 v[100:103], v240 offset:28672
    v_mfma_f32_32x32x16_bf16 v[64:79], v[120:123], v[24:27], 0
    s_waitcnt lgkmcnt(2)
    v_mfma_f32_32x32x16_bf16 v[48:63], v[124:127], v[4:7], v[48:63]
    ds_read_b128 v[120:123], v240 offset:37888
    v_mfma_f32_32x32x16_bf16 v[64:79], v[124:127], v[28:31], v[64:79]
    s_setprio 3
    s_nop 0
    v_cvt_pk_bf16_f32 v80, v80, v81
    v_cvt_pk_bf16_f32 v81, v82, v83
    v_cvt_pk_bf16_f32 v82, v84, v85
    v_cvt_pk_bf16_f32 v83, v86, v87
    s_setprio 1
    s_waitcnt lgkmcnt(2)
    v_mfma_f32_32x32x16_bf16 v[48:63], v[96:99], v[8:11], v[48:63]
    ds_read_b128 v[124:127], v240 offset:47104
    v_mfma_f32_32x32x16_bf16 v[64:79], v[96:99], v[32:35], v[64:79]
    s_setprio 3
    v_cvt_pk_bf16_f32 v84, v88, v89
    v_cvt_pk_bf16_f32 v85, v90, v91
    v_cvt_pk_bf16_f32 v86, v92, v93
    v_cvt_pk_bf16_f32 v87, v94, v95
    s_setprio 1
    s_waitcnt lgkmcnt(2)
    v_mfma_f32_32x32x16_bf16 v[48:63], v[100:103], v[12:15], v[48:63]
    ds_read_b128 v[96:99], v240 offset:2048
    v_mfma_f32_32x32x16_bf16 v[64:79], v[100:103], v[36:39], v[64:79]
    s_setprio 3
    v_cvt_pk_bf16_f32 v104, v104, v105
    v_cvt_pk_bf16_f32 v105, v106, v107
    v_cvt_pk_bf16_f32 v106, v108, v109
    v_cvt_pk_bf16_f32 v107, v110, v111
    s_setprio 1
    s_waitcnt lgkmcnt(2)
    v_mfma_f32_32x32x16_bf16 v[48:63], v[120:123], v[16:19], v[48:63]
    ds_read_b128 v[100:103], v240 offset:11264
    v_mfma_f32_32x32x16_bf16 v[64:79], v[120:123], v[40:43], v[64:79]
    s_setprio 3
    v_cvt_pk_bf16_f32 v108, v112, v113
    v_cvt_pk_bf16_f32 v109, v114, v115
    v_cvt_pk_bf16_f32 v110, v116, v117
    v_cvt_pk_bf16_f32 v111, v118, v119
    s_setprio 1
    s_waitcnt lgkmcnt(2)
    v_mfma_f32_32x32x16_bf16 v[48:63], v[124:127], v[20:23], v[48:63]
    ds_read_b128 v[120:123], v240 offset:20480
    v_mfma_f32_32x32x16_bf16 v[64:79], v[124:127], v[44:47], v[64:79]
    s_setprio 3
    s_nop 8
    v_cvt_pk_bf16_f32 v88, v48, v49
    v_cvt_pk_bf16_f32 v89, v50, v51
    v_cvt_pk_bf16_f32 v90, v52, v53
    v_cvt_pk_bf16_f32 v91, v54, v55
    v_cvt_pk_bf16_f32 v92, v56, v57
    v_cvt_pk_bf16_f32 v93, v58, v59
    v_cvt_pk_bf16_f32 v94, v60, v61
    v_cvt_pk_bf16_f32 v95, v62, v63
    v_cvt_pk_bf16_f32 v112, v64, v65
    v_cvt_pk_bf16_f32 v113, v66, v67
    v_cvt_pk_bf16_f32 v114, v68, v69
    v_cvt_pk_bf16_f32 v115, v70, v71
    v_cvt_pk_bf16_f32 v116, v72, v73
    v_cvt_pk_bf16_f32 v117, v74, v75
    v_cvt_pk_bf16_f32 v118, v76, v77
    v_cvt_pk_bf16_f32 v119, v78, v79
    s_setprio 1
    s_waitcnt lgkmcnt(2)
    v_mfma_f32_32x32x16_bf16 v[48:63], v[96:99], v[0:3], 0
    ds_read_b128 v[124:127], v240 offset:29696
    v_mfma_f32_32x32x16_bf16 v[64:79], v[96:99], v[24:27], 0
    s_waitcnt lgkmcnt(2)
    v_mfma_f32_32x32x16_bf16 v[48:63], v[100:103], v[4:7], v[48:63]
    ds_read_b128 v[96:99], v240 offset:38912
    v_mfma_f32_32x32x16_bf16 v[64:79], v[100:103], v[28:31], v[64:79]
    s_waitcnt lgkmcnt(2)
    v_mfma_f32_32x32x16_bf16 v[48:63], v[120:123], v[8:11], v[48:63]
    ds_read_b128 v[100:103], v240 offset:48128
    v_mfma_f32_32x32x16_bf16 v[64:79], v[120:123], v[32:35], v[64:79]
    s_waitcnt lgkmcnt(2)
    v_mfma_f32_32x32x16_bf16 v[48:63], v[124:127], v[12:15], v[48:63]
    v_mfma_f32_32x32x16_bf16 v[64:79], v[124:127], v[36:39], v[64:79]
    s_waitcnt lgkmcnt(1)
    v_mfma_f32_32x32x16_bf16 v[48:63], v[96:99], v[16:19], v[48:63]
    ds_read_b128 v[0:3], v242 offset:1152
    ds_read_b128 v[4:7], v242 offset:768
    ds_read_b128 v[8:11], v242 offset:384
    ds_read_b128 v[12:15], v242 offset:0
    v_mfma_f32_32x32x16_bf16 v[64:79], v[96:99], v[40:43], v[64:79]
    s_waitcnt lgkmcnt(4)
    v_mfma_f32_32x32x16_bf16 v[48:63], v[100:103], v[20:23], v[48:63]
    v_mfma_f32_32x32x16_bf16 v[64:79], v[100:103], v[44:47], v[64:79]
    s_nop 10
    v_cvt_pk_bf16_f32 v96, v48, v49
    v_cvt_pk_bf16_f32 v97, v50, v51
    v_cvt_pk_bf16_f32 v98, v52, v53
    v_cvt_pk_bf16_f32 v99, v54, v55
    v_cvt_pk_bf16_f32 v100, v56, v57
    v_cvt_pk_bf16_f32 v101, v58, v59
    v_cvt_pk_bf16_f32 v102, v60, v61
    v_cvt_pk_bf16_f32 v103, v62, v63
    v_cvt_pk_bf16_f32 v120, v64, v65
    v_cvt_pk_bf16_f32 v121, v66, v67
    v_cvt_pk_bf16_f32 v122, v68, v69
    v_cvt_pk_bf16_f32 v123, v70, v71
    v_cvt_pk_bf16_f32 v124, v72, v73
    v_cvt_pk_bf16_f32 v125, v74, v75
    v_cvt_pk_bf16_f32 v126, v76, v77
    v_cvt_pk_bf16_f32 v127, v78, v79
    s_waitcnt lgkmcnt(3)
    ds_read_b128 v[0:3], v242 offset:1152
    s_waitcnt lgkmcnt(3)
    ds_read_b128 v[4:7], v242 offset:768
    s_waitcnt lgkmcnt(3)
    ds_read_b128 v[8:11], v242 offset:384
    s_waitcnt lgkmcnt(3)
    ds_read_b128 v[12:15], v242 offset:0
    ds_read_b128 v[16:19], v241 offset:2688
    ds_read_b128 v[20:23], v241 offset:2304
    ds_read_b128 v[24:27], v241 offset:1920
    ds_read_b128 v[28:31], v241 offset:1536
    s_waitcnt lgkmcnt(4)
    v_mfma_f32_32x32x16_bf16 v[0:15], v[128:131], v[80:83], v[0:15]
    v_mfma_f32_32x32x8_bf16 v[0:15], v[132:133], v[84:85], v[0:15]
    s_waitcnt lgkmcnt(0)
    v_mfma_f32_32x32x16_bf16 v[16:31], v[134:137], v[80:83], v[16:31]
    v_mfma_f32_32x32x8_bf16 v[16:31], v[138:139], v[84:85], v[16:31]
    s_nop 8
    v_max_f32 v250, v0, v1
    v_max3_f32 v250, v250, v2, v3
    v_max3_f32 v250, v250, v4, v5
    v_max3_f32 v250, v250, v6, v7
    v_max3_f32 v250, v250, v8, v9
    v_max3_f32 v250, v250, v10, v11
    v_max3_f32 v250, v250, v12, v13
    v_max3_f32 v250, v250, v14, v15
    v_max3_f32 v250, v250, v16, v17
    v_max3_f32 v250, v250, v18, v19
    v_max3_f32 v250, v250, v20, v21
    v_max3_f32 v250, v250, v22, v23
    v_max3_f32 v250, v250, v24, v25
    v_max3_f32 v250, v250, v26, v27
    v_max3_f32 v250, v250, v28, v29
    v_max3_f32 v250, v250, v30, v31
    v_mov_b32 v254, v250
    s_nop 0
    s_nop 0
    v_permlane32_swap_b32 v250, v254
    s_nop 1
    v_max_f32 v250, v250, v254
    v_sub_f32 v0, v0, v250
    v_sub_f32 v1, v1, v250
    v_sub_f32 v2, v2, v250
    v_sub_f32 v3, v3, v250
    v_sub_f32 v4, v4, v250
    v_sub_f32 v5, v5, v250
    v_sub_f32 v6, v6, v250
    v_sub_f32 v7, v7, v250
    v_sub_f32 v8, v8, v250
    v_sub_f32 v9, v9, v250
    v_sub_f32 v10, v10, v250
    v_sub_f32 v11, v11, v250
    v_sub_f32 v12, v12, v250
    v_sub_f32 v13, v13, v250
    v_sub_f32 v14, v14, v250
    v_sub_f32 v15, v15, v250
    v_sub_f32 v16, v16, v250
    v_sub_f32 v17, v17, v250
    v_sub_f32 v18, v18, v250
    v_sub_f32 v19, v19, v250
    v_sub_f32 v20, v20, v250
    v_sub_f32 v21, v21, v250
    v_sub_f32 v22, v22, v250
    v_sub_f32 v23, v23, v250
    v_sub_f32 v24, v24, v250
    v_sub_f32 v25, v25, v250
    v_sub_f32 v26, v26, v250
    v_sub_f32 v27, v27, v250
    v_sub_f32 v28, v28, v250
    v_sub_f32 v29, v29, v250
    v_sub_f32 v30, v30, v250
    v_sub_f32 v31, v31, v250
    v_exp_f32_e32 v0, v0
    v_exp_f32_e32 v1, v1
    v_exp_f32_e32 v2, v2
    v_exp_f32_e32 v3, v3
    v_exp_f32_e32 v4, v4
    v_exp_f32_e32 v5, v5
    v_exp_f32_e32 v6, v6
    v_exp_f32_e32 v7, v7
    v_exp_f32_e32 v8, v8
    v_exp_f32_e32 v9, v9
    v_exp_f32_e32 v10, v10
    v_exp_f32_e32 v11, v11
    v_exp_f32_e32 v12, v12
    v_exp_f32_e32 v13, v13
    v_exp_f32_e32 v14, v14
    v_exp_f32_e32 v15, v15
    v_exp_f32_e32 v16, v16
    v_exp_f32_e32 v17, v17
    v_exp_f32_e32 v18, v18
    v_exp_f32_e32 v19, v19
    v_exp_f32_e32 v20, v20
    v_exp_f32_e32 v21, v21
    v_exp_f32_e32 v22, v22
    v_exp_f32_e32 v23, v23
    v_exp_f32_e32 v24, v24
    v_exp_f32_e32 v25, v25
    v_exp_f32_e32 v26, v26
    v_exp_f32_e32 v27, v27
    v_exp_f32_e32 v28, v28
    v_exp_f32_e32 v29, v29
    v_exp_f32_e32 v30, v30
    v_exp_f32_e32 v31, v31
    v_cvt_pk_bf16_f32 v0, v0, v1
    v_cvt_pk_bf16_f32 v1, v2, v3
    v_cvt_pk_bf16_f32 v2, v4, v5
    v_cvt_pk_bf16_f32 v3, v6, v7
    v_cvt_pk_bf16_f32 v4, v8, v9
    v_cvt_pk_bf16_f32 v5, v10, v11
    v_cvt_pk_bf16_f32 v6, v12, v13
    v_cvt_pk_bf16_f32 v7, v14, v15
    v_cvt_pk_bf16_f32 v16, v16, v17
    v_cvt_pk_bf16_f32 v17, v18, v19
    v_cvt_pk_bf16_f32 v18, v20, v21
    v_cvt_pk_bf16_f32 v19, v22, v23
    v_cvt_pk_bf16_f32 v20, v24, v25
    v_cvt_pk_bf16_f32 v21, v26, v27
    v_cvt_pk_bf16_f32 v22, v28, v29
    v_cvt_pk_bf16_f32 v23, v30, v31
    v_mfma_f32_32x32x16_bf16 v[64:79], v[184:187], v[0:3], 0
    v_mfma_f32_32x32x16_bf16 v[64:79], v[188:191], v[4:7], v[64:79]
    v_mfma_f32_32x32x16_bf16 v[64:79], v[176:179], v[16:19], v[64:79]
    v_mfma_f32_32x32x16_bf16 v[64:79], v[180:183], v[20:23], v[64:79]
    s_nop 11
    v_rcp_f32_e32 v252, v64
    s_nop 0
    v_mul_f32_e32 v68, v68, v252
    v_mul_f32_e32 v69, v69, v252
    v_mul_f32_e32 v70, v70, v252
    v_mul_f32_e32 v71, v71, v252
    v_mul_f32_e32 v72, v72, v252
    v_mul_f32_e32 v73, v73, v252
    v_mul_f32_e32 v74, v74, v252
    v_mul_f32_e32 v75, v75, v252
    v_mul_f32_e32 v76, v76, v252
    v_mul_f32_e32 v77, v77, v252
    v_mul_f32_e32 v78, v78, v252
    v_mul_f32_e32 v79, v79, v252
    v_cvt_pk_bf16_f32 v80, v68, v69
    v_cvt_pk_bf16_f32 v81, v70, v71
    v_cvt_pk_bf16_f32 v82, v72, v73
    v_cvt_pk_bf16_f32 v83, v74, v75
    v_cvt_pk_bf16_f32 v84, v76, v77
    v_cvt_pk_bf16_f32 v85, v78, v79
    ds_read_b128 v[0:3], v241 offset:2688
    ds_read_b128 v[4:7], v241 offset:2304
    ds_read_b128 v[8:11], v241 offset:1920
    ds_read_b128 v[12:15], v241 offset:1536
    ds_read_b128 v[16:19], v242 offset:4224
    ds_read_b128 v[20:23], v242 offset:3840
    ds_read_b128 v[24:27], v242 offset:3456
    ds_read_b128 v[28:31], v242 offset:3072
    s_waitcnt lgkmcnt(4)
    v_mfma_f32_32x32x16_bf16 v[0:15], v[128:131], v[104:107], v[0:15]
    v_mfma_f32_32x32x8_bf16 v[0:15], v[132:133], v[108:109], v[0:15]
    s_waitcnt lgkmcnt(0)
    v_mfma_f32_32x32x16_bf16 v[16:31], v[134:137], v[104:107], v[16:31]
    v_mfma_f32_32x32x8_bf16 v[16:31], v[138:139], v[108:109], v[16:31]
    s_nop 8
    v_max_f32 v250, v0, v1
    v_max3_f32 v250, v250, v2, v3
    v_max3_f32 v250, v250, v4, v5
    v_max3_f32 v250, v250, v6, v7
    v_max3_f32 v250, v250, v8, v9
    v_max3_f32 v250, v250, v10, v11
    v_max3_f32 v250, v250, v12, v13
    v_max3_f32 v250, v250, v14, v15
    v_max3_f32 v250, v250, v16, v17
    v_max3_f32 v250, v250, v18, v19
    v_max3_f32 v250, v250, v20, v21
    v_max3_f32 v250, v250, v22, v23
    v_max3_f32 v250, v250, v24, v25
    v_max3_f32 v250, v250, v26, v27
    v_max3_f32 v250, v250, v28, v29
    v_max3_f32 v250, v250, v30, v31
    v_mov_b32 v254, v250
    s_nop 0
    s_nop 0
    v_permlane32_swap_b32 v250, v254
    s_nop 1
    v_max_f32 v250, v250, v254
    v_sub_f32 v0, v0, v250
    v_sub_f32 v1, v1, v250
    v_sub_f32 v2, v2, v250
    v_sub_f32 v3, v3, v250
    v_sub_f32 v4, v4, v250
    v_sub_f32 v5, v5, v250
    v_sub_f32 v6, v6, v250
    v_sub_f32 v7, v7, v250
    v_sub_f32 v8, v8, v250
    v_sub_f32 v9, v9, v250
    v_sub_f32 v10, v10, v250
    v_sub_f32 v11, v11, v250
    v_sub_f32 v12, v12, v250
    v_sub_f32 v13, v13, v250
    v_sub_f32 v14, v14, v250
    v_sub_f32 v15, v15, v250
    v_sub_f32 v16, v16, v250
    v_sub_f32 v17, v17, v250
    v_sub_f32 v18, v18, v250
    v_sub_f32 v19, v19, v250
    v_sub_f32 v20, v20, v250
    v_sub_f32 v21, v21, v250
    v_sub_f32 v22, v22, v250
    v_sub_f32 v23, v23, v250
    v_sub_f32 v24, v24, v250
    v_sub_f32 v25, v25, v250
    v_sub_f32 v26, v26, v250
    v_sub_f32 v27, v27, v250
    v_sub_f32 v28, v28, v250
    v_sub_f32 v29, v29, v250
    v_sub_f32 v30, v30, v250
    v_sub_f32 v31, v31, v250
    v_exp_f32_e32 v0, v0
    v_exp_f32_e32 v1, v1
    v_exp_f32_e32 v2, v2
    v_exp_f32_e32 v3, v3
    v_exp_f32_e32 v4, v4
    v_exp_f32_e32 v5, v5
    v_exp_f32_e32 v6, v6
    v_exp_f32_e32 v7, v7
    v_exp_f32_e32 v8, v8
    v_exp_f32_e32 v9, v9
    v_exp_f32_e32 v10, v10
    v_exp_f32_e32 v11, v11
    v_exp_f32_e32 v12, v12
    v_exp_f32_e32 v13, v13
    v_exp_f32_e32 v14, v14
    v_exp_f32_e32 v15, v15
    v_exp_f32_e32 v16, v16
    v_exp_f32_e32 v17, v17
    v_exp_f32_e32 v18, v18
    v_exp_f32_e32 v19, v19
    v_exp_f32_e32 v20, v20
    v_exp_f32_e32 v21, v21
    v_exp_f32_e32 v22, v22
    v_exp_f32_e32 v23, v23
    v_exp_f32_e32 v24, v24
    v_exp_f32_e32 v25, v25
    v_exp_f32_e32 v26, v26
    v_exp_f32_e32 v27, v27
    v_exp_f32_e32 v28, v28
    v_exp_f32_e32 v29, v29
    v_exp_f32_e32 v30, v30
    v_exp_f32_e32 v31, v31
    v_cvt_pk_bf16_f32 v0, v0, v1
    v_cvt_pk_bf16_f32 v1, v2, v3
    v_cvt_pk_bf16_f32 v2, v4, v5
    v_cvt_pk_bf16_f32 v3, v6, v7
    v_cvt_pk_bf16_f32 v4, v8, v9
    v_cvt_pk_bf16_f32 v5, v10, v11
    v_cvt_pk_bf16_f32 v6, v12, v13
    v_cvt_pk_bf16_f32 v7, v14, v15
    v_cvt_pk_bf16_f32 v16, v16, v17
    v_cvt_pk_bf16_f32 v17, v18, v19
    v_cvt_pk_bf16_f32 v18, v20, v21
    v_cvt_pk_bf16_f32 v19, v22, v23
    v_cvt_pk_bf16_f32 v20, v24, v25
    v_cvt_pk_bf16_f32 v21, v26, v27
    v_cvt_pk_bf16_f32 v22, v28, v29
    v_cvt_pk_bf16_f32 v23, v30, v31
    v_mfma_f32_32x32x16_bf16 v[64:79], v[184:187], v[0:3], 0
    v_mfma_f32_32x32x16_bf16 v[64:79], v[188:191], v[4:7], v[64:79]
    v_mfma_f32_32x32x16_bf16 v[64:79], v[176:179], v[16:19], v[64:79]
    v_mfma_f32_32x32x16_bf16 v[64:79], v[180:183], v[20:23], v[64:79]
    s_nop 11
    v_rcp_f32_e32 v252, v64
    s_nop 0
    v_mul_f32_e32 v68, v68, v252
    v_mul_f32_e32 v69, v69, v252
    v_mul_f32_e32 v70, v70, v252
    v_mul_f32_e32 v71, v71, v252
    v_mul_f32_e32 v72, v72, v252
    v_mul_f32_e32 v73, v73, v252
    v_mul_f32_e32 v74, v74, v252
    v_mul_f32_e32 v75, v75, v252
    v_mul_f32_e32 v76, v76, v252
    v_mul_f32_e32 v77, v77, v252
    v_mul_f32_e32 v78, v78, v252
    v_mul_f32_e32 v79, v79, v252
    v_cvt_pk_bf16_f32 v104, v68, v69
    v_cvt_pk_bf16_f32 v105, v70, v71
    v_cvt_pk_bf16_f32 v106, v72, v73
    v_cvt_pk_bf16_f32 v107, v74, v75
    v_cvt_pk_bf16_f32 v108, v76, v77
    v_cvt_pk_bf16_f32 v109, v78, v79
    ds_read_b128 v[0:3], v242 offset:1344
    ds_read_b128 v[4:7], v242 offset:960
    ds_read_b128 v[8:11], v242 offset:576
    ds_read_b128 v[12:15], v242 offset:192
    ds_read_b128 v[16:19], v241 offset:2880
    ds_read_b128 v[20:23], v241 offset:2496
    ds_read_b128 v[24:27], v241 offset:2112
    ds_read_b128 v[28:31], v241 offset:1728
    s_waitcnt lgkmcnt(4)
    v_mfma_f32_32x32x16_bf16 v[0:15], v[140:143], v[86:89], v[0:15]
    v_mfma_f32_32x32x8_bf16 v[0:15], v[144:145], v[90:91], v[0:15]
    s_waitcnt lgkmcnt(0)
    v_mfma_f32_32x32x16_bf16 v[16:31], v[146:149], v[86:89], v[16:31]
    v_mfma_f32_32x32x8_bf16 v[16:31], v[150:151], v[90:91], v[16:31]
    s_nop 8
    v_max_f32 v250, v0, v1
    v_max3_f32 v250, v250, v2, v3
    v_max3_f32 v250, v250, v4, v5
    v_max3_f32 v250, v250, v6, v7
    v_max3_f32 v250, v250, v8, v9
    v_max3_f32 v250, v250, v10, v11
    v_max3_f32 v250, v250, v12, v13
    v_max3_f32 v250, v250, v14, v15
    v_max3_f32 v250, v250, v16, v17
    v_max3_f32 v250, v250, v18, v19
    v_max3_f32 v250, v250, v20, v21
    v_max3_f32 v250, v250, v22, v23
    v_max3_f32 v250, v250, v24, v25
    v_max3_f32 v250, v250, v26, v27
    v_max3_f32 v250, v250, v28, v29
    v_max3_f32 v250, v250, v30, v31
    v_mov_b32 v254, v250
    s_nop 0
    s_nop 0
    v_permlane32_swap_b32 v250, v254
    s_nop 1
    v_max_f32 v250, v250, v254
    v_sub_f32 v0, v0, v250
    v_sub_f32 v1, v1, v250
    v_sub_f32 v2, v2, v250
    v_sub_f32 v3, v3, v250
    v_sub_f32 v4, v4, v250
    v_sub_f32 v5, v5, v250
    v_sub_f32 v6, v6, v250
    v_sub_f32 v7, v7, v250
    v_sub_f32 v8, v8, v250
    v_sub_f32 v9, v9, v250
    v_sub_f32 v10, v10, v250
    v_sub_f32 v11, v11, v250
    v_sub_f32 v12, v12, v250
    v_sub_f32 v13, v13, v250
    v_sub_f32 v14, v14, v250
    v_sub_f32 v15, v15, v250
    v_sub_f32 v16, v16, v250
    v_sub_f32 v17, v17, v250
    v_sub_f32 v18, v18, v250
    v_sub_f32 v19, v19, v250
    v_sub_f32 v20, v20, v250
    v_sub_f32 v21, v21, v250
    v_sub_f32 v22, v22, v250
    v_sub_f32 v23, v23, v250
    v_sub_f32 v24, v24, v250
    v_sub_f32 v25, v25, v250
    v_sub_f32 v26, v26, v250
    v_sub_f32 v27, v27, v250
    v_sub_f32 v28, v28, v250
    v_sub_f32 v29, v29, v250
    v_sub_f32 v30, v30, v250
    v_sub_f32 v31, v31, v250
    v_exp_f32_e32 v0, v0
    v_exp_f32_e32 v1, v1
    v_exp_f32_e32 v2, v2
    v_exp_f32_e32 v3, v3
    v_exp_f32_e32 v4, v4
    v_exp_f32_e32 v5, v5
    v_exp_f32_e32 v6, v6
    v_exp_f32_e32 v7, v7
    v_exp_f32_e32 v8, v8
    v_exp_f32_e32 v9, v9
    v_exp_f32_e32 v10, v10
    v_exp_f32_e32 v11, v11
    v_exp_f32_e32 v12, v12
    v_exp_f32_e32 v13, v13
    v_exp_f32_e32 v14, v14
    v_exp_f32_e32 v15, v15
    v_exp_f32_e32 v16, v16
    v_exp_f32_e32 v17, v17
    v_exp_f32_e32 v18, v18
    v_exp_f32_e32 v19, v19
    v_exp_f32_e32 v20, v20
    v_exp_f32_e32 v21, v21
    v_exp_f32_e32 v22, v22
    v_exp_f32_e32 v23, v23
    v_exp_f32_e32 v24, v24
    v_exp_f32_e32 v25, v25
    v_exp_f32_e32 v26, v26
    v_exp_f32_e32 v27, v27
    v_exp_f32_e32 v28, v28
    v_exp_f32_e32 v29, v29
    v_exp_f32_e32 v30, v30
    v_exp_f32_e32 v31, v31
    v_cvt_pk_bf16_f32 v0, v0, v1
    v_cvt_pk_bf16_f32 v1, v2, v3
    v_cvt_pk_bf16_f32 v2, v4, v5
    v_cvt_pk_bf16_f32 v3, v6, v7
    v_cvt_pk_bf16_f32 v4, v8, v9
    v_cvt_pk_bf16_f32 v5, v10, v11
    v_cvt_pk_bf16_f32 v6, v12, v13
    v_cvt_pk_bf16_f32 v7, v14, v15
    v_cvt_pk_bf16_f32 v16, v16, v17
    v_cvt_pk_bf16_f32 v17, v18, v19
    v_cvt_pk_bf16_f32 v18, v20, v21
    v_cvt_pk_bf16_f32 v19, v22, v23
    v_cvt_pk_bf16_f32 v20, v24, v25
    v_cvt_pk_bf16_f32 v21, v26, v27
    v_cvt_pk_bf16_f32 v22, v28, v29
    v_cvt_pk_bf16_f32 v23, v30, v31
    v_mfma_f32_32x32x16_bf16 v[64:79], v[200:203], v[0:3], 0
    v_mfma_f32_32x32x16_bf16 v[64:79], v[204:207], v[4:7], v[64:79]
    v_mfma_f32_32x32x16_bf16 v[64:79], v[192:195], v[16:19], v[64:79]
    v_mfma_f32_32x32x16_bf16 v[64:79], v[196:199], v[20:23], v[64:79]
    s_nop 11
    v_rcp_f32_e32 v252, v68
    s_nop 0
    v_mul_f32_e32 v64, v64, v252
    v_mul_f32_e32 v65, v65, v252
    v_mul_f32_e32 v66, v66, v252
    v_mul_f32_e32 v67, v67, v252
    v_mul_f32_e32 v72, v72, v252
    v_mul_f32_e32 v73, v73, v252
    v_mul_f32_e32 v74, v74, v252
    v_mul_f32_e32 v75, v75, v252
    v_mul_f32_e32 v76, v76, v252
    v_mul_f32_e32 v77, v77, v252
    v_mul_f32_e32 v78, v78, v252
    v_mul_f32_e32 v79, v79, v252
    v_cvt_pk_bf16_f32 v86, v64, v65
    v_cvt_pk_bf16_f32 v87, v66, v67
    v_cvt_pk_bf16_f32 v88, v72, v73
    v_cvt_pk_bf16_f32 v89, v74, v75
    v_cvt_pk_bf16_f32 v90, v76, v77
    v_cvt_pk_bf16_f32 v91, v78, v79
    ds_read_b128 v[0:3], v241 offset:2880
    ds_read_b128 v[4:7], v241 offset:2496
    ds_read_b128 v[8:11], v241 offset:2112
    ds_read_b128 v[12:15], v241 offset:1728
    ds_read_b128 v[16:19], v242 offset:4416
    ds_read_b128 v[20:23], v242 offset:4032
    ds_read_b128 v[24:27], v242 offset:3648
    ds_read_b128 v[28:31], v242 offset:3264
    s_waitcnt lgkmcnt(4)
    v_mfma_f32_32x32x16_bf16 v[0:15], v[140:143], v[110:113], v[0:15]
    v_mfma_f32_32x32x8_bf16 v[0:15], v[144:145], v[114:115], v[0:15]
    s_waitcnt lgkmcnt(0)
    v_mfma_f32_32x32x16_bf16 v[16:31], v[146:149], v[110:113], v[16:31]
    v_mfma_f32_32x32x8_bf16 v[16:31], v[150:151], v[114:115], v[16:31]
    s_nop 8
    v_max_f32 v250, v0, v1
    v_max3_f32 v250, v250, v2, v3
    v_max3_f32 v250, v250, v4, v5
    v_max3_f32 v250, v250, v6, v7
    v_max3_f32 v250, v250, v8, v9
    v_max3_f32 v250, v250, v10, v11
    v_max3_f32 v250, v250, v12, v13
    v_max3_f32 v250, v250, v14, v15
    v_max3_f32 v250, v250, v16, v17
    v_max3_f32 v250, v250, v18, v19
    v_max3_f32 v250, v250, v20, v21
    v_max3_f32 v250, v250, v22, v23
    v_max3_f32 v250, v250, v24, v25
    v_max3_f32 v250, v250, v26, v27
    v_max3_f32 v250, v250, v28, v29
    v_max3_f32 v250, v250, v30, v31
    v_mov_b32 v254, v250
    s_nop 0
    s_nop 0
    v_permlane32_swap_b32 v250, v254
    s_nop 1
    v_max_f32 v250, v250, v254
    v_sub_f32 v0, v0, v250
    v_sub_f32 v1, v1, v250
    v_sub_f32 v2, v2, v250
    v_sub_f32 v3, v3, v250
    v_sub_f32 v4, v4, v250
    v_sub_f32 v5, v5, v250
    v_sub_f32 v6, v6, v250
    v_sub_f32 v7, v7, v250
    v_sub_f32 v8, v8, v250
    v_sub_f32 v9, v9, v250
    v_sub_f32 v10, v10, v250
    v_sub_f32 v11, v11, v250
    v_sub_f32 v12, v12, v250
    v_sub_f32 v13, v13, v250
    v_sub_f32 v14, v14, v250
    v_sub_f32 v15, v15, v250
    v_sub_f32 v16, v16, v250
    v_sub_f32 v17, v17, v250
    v_sub_f32 v18, v18, v250
    v_sub_f32 v19, v19, v250
    v_sub_f32 v20, v20, v250
    v_sub_f32 v21, v21, v250
    v_sub_f32 v22, v22, v250
    v_sub_f32 v23, v23, v250
    v_sub_f32 v24, v24, v250
    v_sub_f32 v25, v25, v250
    v_sub_f32 v26, v26, v250
    v_sub_f32 v27, v27, v250
    v_sub_f32 v28, v28, v250
    v_sub_f32 v29, v29, v250
    v_sub_f32 v30, v30, v250
    v_sub_f32 v31, v31, v250
    v_exp_f32_e32 v0, v0
    v_exp_f32_e32 v1, v1
    v_exp_f32_e32 v2, v2
    v_exp_f32_e32 v3, v3
    v_exp_f32_e32 v4, v4
    v_exp_f32_e32 v5, v5
    v_exp_f32_e32 v6, v6
    v_exp_f32_e32 v7, v7
    v_exp_f32_e32 v8, v8
    v_exp_f32_e32 v9, v9
    v_exp_f32_e32 v10, v10
    v_exp_f32_e32 v11, v11
    v_exp_f32_e32 v12, v12
    v_exp_f32_e32 v13, v13
    v_exp_f32_e32 v14, v14
    v_exp_f32_e32 v15, v15
    v_exp_f32_e32 v16, v16
    v_exp_f32_e32 v17, v17
    v_exp_f32_e32 v18, v18
    v_exp_f32_e32 v19, v19
    v_exp_f32_e32 v20, v20
    v_exp_f32_e32 v21, v21
    v_exp_f32_e32 v22, v22
    v_exp_f32_e32 v23, v23
    v_exp_f32_e32 v24, v24
    v_exp_f32_e32 v25, v25
    v_exp_f32_e32 v26, v26
    v_exp_f32_e32 v27, v27
    v_exp_f32_e32 v28, v28
    v_exp_f32_e32 v29, v29
    v_exp_f32_e32 v30, v30
    v_exp_f32_e32 v31, v31
    v_cvt_pk_bf16_f32 v0, v0, v1
    v_cvt_pk_bf16_f32 v1, v2, v3
    v_cvt_pk_bf16_f32 v2, v4, v5
    v_cvt_pk_bf16_f32 v3, v6, v7
    v_cvt_pk_bf16_f32 v4, v8, v9
    v_cvt_pk_bf16_f32 v5, v10, v11
    v_cvt_pk_bf16_f32 v6, v12, v13
    v_cvt_pk_bf16_f32 v7, v14, v15
    v_cvt_pk_bf16_f32 v16, v16, v17
    v_cvt_pk_bf16_f32 v17, v18, v19
    v_cvt_pk_bf16_f32 v18, v20, v21
    v_cvt_pk_bf16_f32 v19, v22, v23
    v_cvt_pk_bf16_f32 v20, v24, v25
    v_cvt_pk_bf16_f32 v21, v26, v27
    v_cvt_pk_bf16_f32 v22, v28, v29
    v_cvt_pk_bf16_f32 v23, v30, v31
    v_mfma_f32_32x32x16_bf16 v[64:79], v[200:203], v[0:3], 0
    v_mfma_f32_32x32x16_bf16 v[64:79], v[204:207], v[4:7], v[64:79]
    v_mfma_f32_32x32x16_bf16 v[64:79], v[192:195], v[16:19], v[64:79]
    v_mfma_f32_32x32x16_bf16 v[64:79], v[196:199], v[20:23], v[64:79]
    s_nop 11
    v_rcp_f32_e32 v252, v68
    s_nop 0
    v_mul_f32_e32 v64, v64, v252
    v_mul_f32_e32 v65, v65, v252
    v_mul_f32_e32 v66, v66, v252
    v_mul_f32_e32 v67, v67, v252
    v_mul_f32_e32 v72, v72, v252
    v_mul_f32_e32 v73, v73, v252
    v_mul_f32_e32 v74, v74, v252
    v_mul_f32_e32 v75, v75, v252
    v_mul_f32_e32 v76, v76, v252
    v_mul_f32_e32 v77, v77, v252
    v_mul_f32_e32 v78, v78, v252
    v_mul_f32_e32 v79, v79, v252
    v_cvt_pk_bf16_f32 v110, v64, v65
    v_cvt_pk_bf16_f32 v111, v66, v67
    v_cvt_pk_bf16_f32 v112, v72, v73
    v_cvt_pk_bf16_f32 v113, v74, v75
    v_cvt_pk_bf16_f32 v114, v76, v77
    v_cvt_pk_bf16_f32 v115, v78, v79
    ds_read_b128 v[0:3], v242 offset:6912
    ds_read_b128 v[4:7], v242 offset:6528
    ds_read_b128 v[8:11], v242 offset:6144
    ds_read_b128 v[12:15], v242 offset:5760
    ds_read_b128 v[16:19], v241 offset:8448
    ds_read_b128 v[20:23], v241 offset:8064
    ds_read_b128 v[24:27], v241 offset:7680
    ds_read_b128 v[28:31], v241 offset:7296
    s_waitcnt lgkmcnt(4)
    v_mfma_f32_32x32x16_bf16 v[0:15], v[152:155], v[92:95], v[0:15]
    v_mfma_f32_32x32x8_bf16 v[0:15], v[156:157], v[96:97], v[0:15]
    s_waitcnt lgkmcnt(0)
    v_mfma_f32_32x32x16_bf16 v[16:31], v[158:161], v[92:95], v[16:31]
    v_mfma_f32_32x32x8_bf16 v[16:31], v[162:163], v[96:97], v[16:31]
    s_nop 8
    v_max_f32 v250, v0, v1
    v_max3_f32 v250, v250, v2, v3
    v_max3_f32 v250, v250, v4, v5
    v_max3_f32 v250, v250, v6, v7
    v_max3_f32 v250, v250, v8, v9
    v_max3_f32 v250, v250, v10, v11
    v_max3_f32 v250, v250, v12, v13
    v_max3_f32 v250, v250, v14, v15
    v_max3_f32 v250, v250, v16, v17
    v_max3_f32 v250, v250, v18, v19
    v_max3_f32 v250, v250, v20, v21
    v_max3_f32 v250, v250, v22, v23
    v_max3_f32 v250, v250, v24, v25
    v_max3_f32 v250, v250, v26, v27
    v_max3_f32 v250, v250, v28, v29
    v_max3_f32 v250, v250, v30, v31
    v_mov_b32 v254, v250
    s_nop 0
    s_nop 0
    v_permlane32_swap_b32 v250, v254
    s_nop 1
    v_max_f32 v250, v250, v254
    v_sub_f32 v0, v0, v250
    v_sub_f32 v1, v1, v250
    v_sub_f32 v2, v2, v250
    v_sub_f32 v3, v3, v250
    v_sub_f32 v4, v4, v250
    v_sub_f32 v5, v5, v250
    v_sub_f32 v6, v6, v250
    v_sub_f32 v7, v7, v250
    v_sub_f32 v8, v8, v250
    v_sub_f32 v9, v9, v250
    v_sub_f32 v10, v10, v250
    v_sub_f32 v11, v11, v250
    v_sub_f32 v12, v12, v250
    v_sub_f32 v13, v13, v250
    v_sub_f32 v14, v14, v250
    v_sub_f32 v15, v15, v250
    v_sub_f32 v16, v16, v250
    v_sub_f32 v17, v17, v250
    v_sub_f32 v18, v18, v250
    v_sub_f32 v19, v19, v250
    v_sub_f32 v20, v20, v250
    v_sub_f32 v21, v21, v250
    v_sub_f32 v22, v22, v250
    v_sub_f32 v23, v23, v250
    v_sub_f32 v24, v24, v250
    v_sub_f32 v25, v25, v250
    v_sub_f32 v26, v26, v250
    v_sub_f32 v27, v27, v250
    v_sub_f32 v28, v28, v250
    v_sub_f32 v29, v29, v250
    v_sub_f32 v30, v30, v250
    v_sub_f32 v31, v31, v250
    v_exp_f32_e32 v0, v0
    v_exp_f32_e32 v1, v1
    v_exp_f32_e32 v2, v2
    v_exp_f32_e32 v3, v3
    v_exp_f32_e32 v4, v4
    v_exp_f32_e32 v5, v5
    v_exp_f32_e32 v6, v6
    v_exp_f32_e32 v7, v7
    v_exp_f32_e32 v8, v8
    v_exp_f32_e32 v9, v9
    v_exp_f32_e32 v10, v10
    v_exp_f32_e32 v11, v11
    v_exp_f32_e32 v12, v12
    v_exp_f32_e32 v13, v13
    v_exp_f32_e32 v14, v14
    v_exp_f32_e32 v15, v15
    v_exp_f32_e32 v16, v16
    v_exp_f32_e32 v17, v17
    v_exp_f32_e32 v18, v18
    v_exp_f32_e32 v19, v19
    v_exp_f32_e32 v20, v20
    v_exp_f32_e32 v21, v21
    v_exp_f32_e32 v22, v22
    v_exp_f32_e32 v23, v23
    v_exp_f32_e32 v24, v24
    v_exp_f32_e32 v25, v25
    v_exp_f32_e32 v26, v26
    v_exp_f32_e32 v27, v27
    v_exp_f32_e32 v28, v28
    v_exp_f32_e32 v29, v29
    v_exp_f32_e32 v30, v30
    v_exp_f32_e32 v31, v31
    v_cvt_pk_bf16_f32 v0, v0, v1
    v_cvt_pk_bf16_f32 v1, v2, v3
    v_cvt_pk_bf16_f32 v2, v4, v5
    v_cvt_pk_bf16_f32 v3, v6, v7
    v_cvt_pk_bf16_f32 v4, v8, v9
    v_cvt_pk_bf16_f32 v5, v10, v11
    v_cvt_pk_bf16_f32 v6, v12, v13
    v_cvt_pk_bf16_f32 v7, v14, v15
    v_cvt_pk_bf16_f32 v16, v16, v17
    v_cvt_pk_bf16_f32 v17, v18, v19
    v_cvt_pk_bf16_f32 v18, v20, v21
    v_cvt_pk_bf16_f32 v19, v22, v23
    v_cvt_pk_bf16_f32 v20, v24, v25
    v_cvt_pk_bf16_f32 v21, v26, v27
    v_cvt_pk_bf16_f32 v22, v28, v29
    v_cvt_pk_bf16_f32 v23, v30, v31
    v_mfma_f32_32x32x16_bf16 v[64:79], v[216:219], v[0:3], 0
    v_mfma_f32_32x32x16_bf16 v[64:79], v[220:223], v[4:7], v[64:79]
    v_mfma_f32_32x32x16_bf16 v[64:79], v[208:211], v[16:19], v[64:79]
    v_mfma_f32_32x32x16_bf16 v[64:79], v[212:215], v[20:23], v[64:79]
    s_nop 11
    v_rcp_f32_e32 v252, v72
    s_nop 0
    v_mul_f32_e32 v64, v64, v252
    v_mul_f32_e32 v65, v65, v252
    v_mul_f32_e32 v66, v66, v252
    v_mul_f32_e32 v67, v67, v252
    v_mul_f32_e32 v68, v68, v252
    v_mul_f32_e32 v69, v69, v252
    v_mul_f32_e32 v70, v70, v252
    v_mul_f32_e32 v71, v71, v252
    v_mul_f32_e32 v76, v76, v252
    v_mul_f32_e32 v77, v77, v252
    v_mul_f32_e32 v78, v78, v252
    v_mul_f32_e32 v79, v79, v252
    v_cvt_pk_bf16_f32 v92, v64, v65
    v_cvt_pk_bf16_f32 v93, v66, v67
    v_cvt_pk_bf16_f32 v94, v68, v69
    v_cvt_pk_bf16_f32 v95, v70, v71
    v_cvt_pk_bf16_f32 v96, v76, v77
    v_cvt_pk_bf16_f32 v97, v78, v79
    ds_read_b128 v[0:3], v241 offset:8448
    ds_read_b128 v[4:7], v241 offset:8064
    ds_read_b128 v[8:11], v241 offset:7680
    ds_read_b128 v[12:15], v241 offset:7296
    ds_read_b128 v[16:19], v242 offset:9984
    ds_read_b128 v[20:23], v242 offset:9600
    ds_read_b128 v[24:27], v242 offset:9216
    ds_read_b128 v[28:31], v242 offset:8832
    s_waitcnt lgkmcnt(4)
    v_mfma_f32_32x32x16_bf16 v[0:15], v[152:155], v[116:119], v[0:15]
    v_mfma_f32_32x32x8_bf16 v[0:15], v[156:157], v[120:121], v[0:15]
    s_waitcnt lgkmcnt(0)
    v_mfma_f32_32x32x16_bf16 v[16:31], v[158:161], v[116:119], v[16:31]
    v_mfma_f32_32x32x8_bf16 v[16:31], v[162:163], v[120:121], v[16:31]
    s_nop 8
    v_max_f32 v250, v0, v1
    v_max3_f32 v250, v250, v2, v3
    v_max3_f32 v250, v250, v4, v5
    v_max3_f32 v250, v250, v6, v7
    v_max3_f32 v250, v250, v8, v9
    v_max3_f32 v250, v250, v10, v11
    v_max3_f32 v250, v250, v12, v13
    v_max3_f32 v250, v250, v14, v15
    v_max3_f32 v250, v250, v16, v17
    v_max3_f32 v250, v250, v18, v19
    v_max3_f32 v250, v250, v20, v21
    v_max3_f32 v250, v250, v22, v23
    v_max3_f32 v250, v250, v24, v25
    v_max3_f32 v250, v250, v26, v27
    v_max3_f32 v250, v250, v28, v29
    v_max3_f32 v250, v250, v30, v31
    v_mov_b32 v254, v250
    s_nop 0
    s_nop 0
    v_permlane32_swap_b32 v250, v254
    s_nop 1
    v_max_f32 v250, v250, v254
    v_sub_f32 v0, v0, v250
    v_sub_f32 v1, v1, v250
    v_sub_f32 v2, v2, v250
    v_sub_f32 v3, v3, v250
    v_sub_f32 v4, v4, v250
    v_sub_f32 v5, v5, v250
    v_sub_f32 v6, v6, v250
    v_sub_f32 v7, v7, v250
    v_sub_f32 v8, v8, v250
    v_sub_f32 v9, v9, v250
    v_sub_f32 v10, v10, v250
    v_sub_f32 v11, v11, v250
    v_sub_f32 v12, v12, v250
    v_sub_f32 v13, v13, v250
    v_sub_f32 v14, v14, v250
    v_sub_f32 v15, v15, v250
    v_sub_f32 v16, v16, v250
    v_sub_f32 v17, v17, v250
    v_sub_f32 v18, v18, v250
    v_sub_f32 v19, v19, v250
    v_sub_f32 v20, v20, v250
    v_sub_f32 v21, v21, v250
    v_sub_f32 v22, v22, v250
    v_sub_f32 v23, v23, v250
    v_sub_f32 v24, v24, v250
    v_sub_f32 v25, v25, v250
    v_sub_f32 v26, v26, v250
    v_sub_f32 v27, v27, v250
    v_sub_f32 v28, v28, v250
    v_sub_f32 v29, v29, v250
    v_sub_f32 v30, v30, v250
    v_sub_f32 v31, v31, v250
    v_exp_f32_e32 v0, v0
    v_exp_f32_e32 v1, v1
    v_exp_f32_e32 v2, v2
    v_exp_f32_e32 v3, v3
    v_exp_f32_e32 v4, v4
    v_exp_f32_e32 v5, v5
    v_exp_f32_e32 v6, v6
    v_exp_f32_e32 v7, v7
    v_exp_f32_e32 v8, v8
    v_exp_f32_e32 v9, v9
    v_exp_f32_e32 v10, v10
    v_exp_f32_e32 v11, v11
    v_exp_f32_e32 v12, v12
    v_exp_f32_e32 v13, v13
    v_exp_f32_e32 v14, v14
    v_exp_f32_e32 v15, v15
    v_exp_f32_e32 v16, v16
    v_exp_f32_e32 v17, v17
    v_exp_f32_e32 v18, v18
    v_exp_f32_e32 v19, v19
    v_exp_f32_e32 v20, v20
    v_exp_f32_e32 v21, v21
    v_exp_f32_e32 v22, v22
    v_exp_f32_e32 v23, v23
    v_exp_f32_e32 v24, v24
    v_exp_f32_e32 v25, v25
    v_exp_f32_e32 v26, v26
    v_exp_f32_e32 v27, v27
    v_exp_f32_e32 v28, v28
    v_exp_f32_e32 v29, v29
    v_exp_f32_e32 v30, v30
    v_exp_f32_e32 v31, v31
    v_cvt_pk_bf16_f32 v0, v0, v1
    v_cvt_pk_bf16_f32 v1, v2, v3
    v_cvt_pk_bf16_f32 v2, v4, v5
    v_cvt_pk_bf16_f32 v3, v6, v7
    v_cvt_pk_bf16_f32 v4, v8, v9
    v_cvt_pk_bf16_f32 v5, v10, v11
    v_cvt_pk_bf16_f32 v6, v12, v13
    v_cvt_pk_bf16_f32 v7, v14, v15
    v_cvt_pk_bf16_f32 v16, v16, v17
    v_cvt_pk_bf16_f32 v17, v18, v19
    v_cvt_pk_bf16_f32 v18, v20, v21
    v_cvt_pk_bf16_f32 v19, v22, v23
    v_cvt_pk_bf16_f32 v20, v24, v25
    v_cvt_pk_bf16_f32 v21, v26, v27
    v_cvt_pk_bf16_f32 v22, v28, v29
    v_cvt_pk_bf16_f32 v23, v30, v31
    v_mfma_f32_32x32x16_bf16 v[64:79], v[216:219], v[0:3], 0
    v_mfma_f32_32x32x16_bf16 v[64:79], v[220:223], v[4:7], v[64:79]
    v_mfma_f32_32x32x16_bf16 v[64:79], v[208:211], v[16:19], v[64:79]
    v_mfma_f32_32x32x16_bf16 v[64:79], v[212:215], v[20:23], v[64:79]
    s_nop 11
    v_rcp_f32_e32 v252, v72
    s_nop 0
    v_mul_f32_e32 v64, v64, v252
    v_mul_f32_e32 v65, v65, v252
    v_mul_f32_e32 v66, v66, v252
    v_mul_f32_e32 v67, v67, v252
    v_mul_f32_e32 v68, v68, v252
    v_mul_f32_e32 v69, v69, v252
    v_mul_f32_e32 v70, v70, v252
    v_mul_f32_e32 v71, v71, v252
    v_mul_f32_e32 v76, v76, v252
    v_mul_f32_e32 v77, v77, v252
    v_mul_f32_e32 v78, v78, v252
    v_mul_f32_e32 v79, v79, v252
    v_cvt_pk_bf16_f32 v116, v64, v65
    v_cvt_pk_bf16_f32 v117, v66, v67
    v_cvt_pk_bf16_f32 v118, v68, v69
    v_cvt_pk_bf16_f32 v119, v70, v71
    v_cvt_pk_bf16_f32 v120, v76, v77
    v_cvt_pk_bf16_f32 v121, v78, v79
    ds_read_b128 v[0:3], v242 offset:7104
    ds_read_b128 v[4:7], v242 offset:6720
    ds_read_b128 v[8:11], v242 offset:6336
    ds_read_b128 v[12:15], v242 offset:5952
    ds_read_b128 v[16:19], v241 offset:8640
    ds_read_b128 v[20:23], v241 offset:8256
    ds_read_b128 v[24:27], v241 offset:7872
    ds_read_b128 v[28:31], v241 offset:7488
    s_waitcnt lgkmcnt(4)
    v_mfma_f32_32x32x16_bf16 v[0:15], v[164:167], v[98:101], v[0:15]
    v_mfma_f32_32x32x8_bf16 v[0:15], v[168:169], v[102:103], v[0:15]
    s_waitcnt lgkmcnt(0)
    v_mfma_f32_32x32x16_bf16 v[16:31], v[170:173], v[98:101], v[16:31]
    v_mfma_f32_32x32x8_bf16 v[16:31], v[174:175], v[102:103], v[16:31]
    s_nop 8
    v_max_f32 v250, v0, v1
    v_max3_f32 v250, v250, v2, v3
    v_max3_f32 v250, v250, v4, v5
    v_max3_f32 v250, v250, v6, v7
    v_max3_f32 v250, v250, v8, v9
    v_max3_f32 v250, v250, v10, v11
    v_max3_f32 v250, v250, v12, v13
    v_max3_f32 v250, v250, v14, v15
    v_max3_f32 v250, v250, v16, v17
    v_max3_f32 v250, v250, v18, v19
    v_max3_f32 v250, v250, v20, v21
    v_max3_f32 v250, v250, v22, v23
    v_max3_f32 v250, v250, v24, v25
    v_max3_f32 v250, v250, v26, v27
    v_max3_f32 v250, v250, v28, v29
    v_max3_f32 v250, v250, v30, v31
    v_mov_b32 v254, v250
    s_nop 0
    s_nop 0
    v_permlane32_swap_b32 v250, v254
    s_nop 1
    v_max_f32 v250, v250, v254
    v_sub_f32 v0, v0, v250
    v_sub_f32 v1, v1, v250
    v_sub_f32 v2, v2, v250
    v_sub_f32 v3, v3, v250
    v_sub_f32 v4, v4, v250
    v_sub_f32 v5, v5, v250
    v_sub_f32 v6, v6, v250
    v_sub_f32 v7, v7, v250
    v_sub_f32 v8, v8, v250
    v_sub_f32 v9, v9, v250
    v_sub_f32 v10, v10, v250
    v_sub_f32 v11, v11, v250
    v_sub_f32 v12, v12, v250
    v_sub_f32 v13, v13, v250
    v_sub_f32 v14, v14, v250
    v_sub_f32 v15, v15, v250
    v_sub_f32 v16, v16, v250
    v_sub_f32 v17, v17, v250
    v_sub_f32 v18, v18, v250
    v_sub_f32 v19, v19, v250
    v_sub_f32 v20, v20, v250
    v_sub_f32 v21, v21, v250
    v_sub_f32 v22, v22, v250
    v_sub_f32 v23, v23, v250
    v_sub_f32 v24, v24, v250
    v_sub_f32 v25, v25, v250
    v_sub_f32 v26, v26, v250
    v_sub_f32 v27, v27, v250
    v_sub_f32 v28, v28, v250
    v_sub_f32 v29, v29, v250
    v_sub_f32 v30, v30, v250
    v_sub_f32 v31, v31, v250
    v_exp_f32_e32 v0, v0
    v_exp_f32_e32 v1, v1
    v_exp_f32_e32 v2, v2
    v_exp_f32_e32 v3, v3
    v_exp_f32_e32 v4, v4
    v_exp_f32_e32 v5, v5
    v_exp_f32_e32 v6, v6
    v_exp_f32_e32 v7, v7
    v_exp_f32_e32 v8, v8
    v_exp_f32_e32 v9, v9
    v_exp_f32_e32 v10, v10
    v_exp_f32_e32 v11, v11
    v_exp_f32_e32 v12, v12
    v_exp_f32_e32 v13, v13
    v_exp_f32_e32 v14, v14
    v_exp_f32_e32 v15, v15
    v_exp_f32_e32 v16, v16
    v_exp_f32_e32 v17, v17
    v_exp_f32_e32 v18, v18
    v_exp_f32_e32 v19, v19
    v_exp_f32_e32 v20, v20
    v_exp_f32_e32 v21, v21
    v_exp_f32_e32 v22, v22
    v_exp_f32_e32 v23, v23
    v_exp_f32_e32 v24, v24
    v_exp_f32_e32 v25, v25
    v_exp_f32_e32 v26, v26
    v_exp_f32_e32 v27, v27
    v_exp_f32_e32 v28, v28
    v_exp_f32_e32 v29, v29
    v_exp_f32_e32 v30, v30
    v_exp_f32_e32 v31, v31
    v_cvt_pk_bf16_f32 v0, v0, v1
    v_cvt_pk_bf16_f32 v1, v2, v3
    v_cvt_pk_bf16_f32 v2, v4, v5
    v_cvt_pk_bf16_f32 v3, v6, v7
    v_cvt_pk_bf16_f32 v4, v8, v9
    v_cvt_pk_bf16_f32 v5, v10, v11
    v_cvt_pk_bf16_f32 v6, v12, v13
    v_cvt_pk_bf16_f32 v7, v14, v15
    v_cvt_pk_bf16_f32 v16, v16, v17
    v_cvt_pk_bf16_f32 v17, v18, v19
    v_cvt_pk_bf16_f32 v18, v20, v21
    v_cvt_pk_bf16_f32 v19, v22, v23
    v_cvt_pk_bf16_f32 v20, v24, v25
    v_cvt_pk_bf16_f32 v21, v26, v27
    v_cvt_pk_bf16_f32 v22, v28, v29
    v_cvt_pk_bf16_f32 v23, v30, v31
    v_mfma_f32_32x32x16_bf16 v[64:79], v[232:235], v[0:3], 0
    v_mfma_f32_32x32x16_bf16 v[64:79], v[236:239], v[4:7], v[64:79]
    v_mfma_f32_32x32x16_bf16 v[64:79], v[224:227], v[16:19], v[64:79]
    v_mfma_f32_32x32x16_bf16 v[64:79], v[228:231], v[20:23], v[64:79]
    s_nop 11
    v_rcp_f32_e32 v252, v76
    s_nop 0
    v_mul_f32_e32 v64, v64, v252
    v_mul_f32_e32 v65, v65, v252
    v_mul_f32_e32 v66, v66, v252
    v_mul_f32_e32 v67, v67, v252
    v_mul_f32_e32 v68, v68, v252
    v_mul_f32_e32 v69, v69, v252
    v_mul_f32_e32 v70, v70, v252
    v_mul_f32_e32 v71, v71, v252
    v_mul_f32_e32 v72, v72, v252
    v_mul_f32_e32 v73, v73, v252
    v_mul_f32_e32 v74, v74, v252
    v_mul_f32_e32 v75, v75, v252
    v_cvt_pk_bf16_f32 v98, v64, v65
    v_cvt_pk_bf16_f32 v99, v66, v67
    v_cvt_pk_bf16_f32 v100, v68, v69
    v_cvt_pk_bf16_f32 v101, v70, v71
    v_cvt_pk_bf16_f32 v102, v72, v73
    v_cvt_pk_bf16_f32 v103, v74, v75
    ds_read_b128 v[0:3], v241 offset:8640
    ds_read_b128 v[4:7], v241 offset:8256
    ds_read_b128 v[8:11], v241 offset:7872
    ds_read_b128 v[12:15], v241 offset:7488
    ds_read_b128 v[16:19], v242 offset:10176
    ds_read_b128 v[20:23], v242 offset:9792
    ds_read_b128 v[24:27], v242 offset:9408
    ds_read_b128 v[28:31], v242 offset:9024
    s_waitcnt lgkmcnt(4)
    v_mfma_f32_32x32x16_bf16 v[0:15], v[164:167], v[122:125], v[0:15]
    v_mfma_f32_32x32x8_bf16 v[0:15], v[168:169], v[126:127], v[0:15]
    s_waitcnt lgkmcnt(0)
    v_mfma_f32_32x32x16_bf16 v[16:31], v[170:173], v[122:125], v[16:31]
    v_mfma_f32_32x32x8_bf16 v[16:31], v[174:175], v[126:127], v[16:31]
    s_nop 8
    v_max_f32 v250, v0, v1
    v_max3_f32 v250, v250, v2, v3
    v_max3_f32 v250, v250, v4, v5
    v_max3_f32 v250, v250, v6, v7
    v_max3_f32 v250, v250, v8, v9
    v_max3_f32 v250, v250, v10, v11
    v_max3_f32 v250, v250, v12, v13
    v_max3_f32 v250, v250, v14, v15
    v_max3_f32 v250, v250, v16, v17
    v_max3_f32 v250, v250, v18, v19
    v_max3_f32 v250, v250, v20, v21
    v_max3_f32 v250, v250, v22, v23
    v_max3_f32 v250, v250, v24, v25
    v_max3_f32 v250, v250, v26, v27
    v_max3_f32 v250, v250, v28, v29
    v_max3_f32 v250, v250, v30, v31
    v_mov_b32 v254, v250
    s_nop 0
    s_nop 0
    v_permlane32_swap_b32 v250, v254
    s_nop 1
    v_max_f32 v250, v250, v254
    v_sub_f32 v0, v0, v250
    v_sub_f32 v1, v1, v250
    v_sub_f32 v2, v2, v250
    v_sub_f32 v3, v3, v250
    v_sub_f32 v4, v4, v250
    v_sub_f32 v5, v5, v250
    v_sub_f32 v6, v6, v250
    v_sub_f32 v7, v7, v250
    v_sub_f32 v8, v8, v250
    v_sub_f32 v9, v9, v250
    v_sub_f32 v10, v10, v250
    v_sub_f32 v11, v11, v250
    v_sub_f32 v12, v12, v250
    v_sub_f32 v13, v13, v250
    v_sub_f32 v14, v14, v250
    v_sub_f32 v15, v15, v250
    v_sub_f32 v16, v16, v250
    v_sub_f32 v17, v17, v250
    v_sub_f32 v18, v18, v250
    v_sub_f32 v19, v19, v250
    v_sub_f32 v20, v20, v250
    v_sub_f32 v21, v21, v250
    v_sub_f32 v22, v22, v250
    v_sub_f32 v23, v23, v250
    v_sub_f32 v24, v24, v250
    v_sub_f32 v25, v25, v250
    v_sub_f32 v26, v26, v250
    v_sub_f32 v27, v27, v250
    v_sub_f32 v28, v28, v250
    v_sub_f32 v29, v29, v250
    v_sub_f32 v30, v30, v250
    v_sub_f32 v31, v31, v250
    v_exp_f32_e32 v0, v0
    v_exp_f32_e32 v1, v1
    v_exp_f32_e32 v2, v2
    v_exp_f32_e32 v3, v3
    v_exp_f32_e32 v4, v4
    v_exp_f32_e32 v5, v5
    v_exp_f32_e32 v6, v6
    v_exp_f32_e32 v7, v7
    v_exp_f32_e32 v8, v8
    v_exp_f32_e32 v9, v9
    v_exp_f32_e32 v10, v10
    v_exp_f32_e32 v11, v11
    v_exp_f32_e32 v12, v12
    v_exp_f32_e32 v13, v13
    v_exp_f32_e32 v14, v14
    v_exp_f32_e32 v15, v15
    v_exp_f32_e32 v16, v16
    v_exp_f32_e32 v17, v17
    v_exp_f32_e32 v18, v18
    v_exp_f32_e32 v19, v19
    v_exp_f32_e32 v20, v20
    v_exp_f32_e32 v21, v21
    v_exp_f32_e32 v22, v22
    v_exp_f32_e32 v23, v23
    v_exp_f32_e32 v24, v24
    v_exp_f32_e32 v25, v25
    v_exp_f32_e32 v26, v26
    v_exp_f32_e32 v27, v27
    v_exp_f32_e32 v28, v28
    v_exp_f32_e32 v29, v29
    v_exp_f32_e32 v30, v30
    v_exp_f32_e32 v31, v31
    v_cvt_pk_bf16_f32 v0, v0, v1
    v_cvt_pk_bf16_f32 v1, v2, v3
    v_cvt_pk_bf16_f32 v2, v4, v5
    v_cvt_pk_bf16_f32 v3, v6, v7
    v_cvt_pk_bf16_f32 v4, v8, v9
    v_cvt_pk_bf16_f32 v5, v10, v11
    v_cvt_pk_bf16_f32 v6, v12, v13
    v_cvt_pk_bf16_f32 v7, v14, v15
    v_cvt_pk_bf16_f32 v16, v16, v17
    v_cvt_pk_bf16_f32 v17, v18, v19
    v_cvt_pk_bf16_f32 v18, v20, v21
    v_cvt_pk_bf16_f32 v19, v22, v23
    v_cvt_pk_bf16_f32 v20, v24, v25
    v_cvt_pk_bf16_f32 v21, v26, v27
    v_cvt_pk_bf16_f32 v22, v28, v29
    v_cvt_pk_bf16_f32 v23, v30, v31
    v_mfma_f32_32x32x16_bf16 v[64:79], v[232:235], v[0:3], 0
    v_mfma_f32_32x32x16_bf16 v[64:79], v[236:239], v[4:7], v[64:79]
    v_mfma_f32_32x32x16_bf16 v[64:79], v[224:227], v[16:19], v[64:79]
    v_mfma_f32_32x32x16_bf16 v[64:79], v[228:231], v[20:23], v[64:79]
    s_nop 11
    v_rcp_f32_e32 v252, v76
    s_nop 0
    v_mul_f32_e32 v64, v64, v252
    v_mul_f32_e32 v65, v65, v252
    v_mul_f32_e32 v66, v66, v252
    v_mul_f32_e32 v67, v67, v252
    v_mul_f32_e32 v68, v68, v252
    v_mul_f32_e32 v69, v69, v252
    v_mul_f32_e32 v70, v70, v252
    v_mul_f32_e32 v71, v71, v252
    v_mul_f32_e32 v72, v72, v252
    v_mul_f32_e32 v73, v73, v252
    v_mul_f32_e32 v74, v74, v252
    v_mul_f32_e32 v75, v75, v252
    v_cvt_pk_bf16_f32 v122, v64, v65
    v_cvt_pk_bf16_f32 v123, v66, v67
    v_cvt_pk_bf16_f32 v124, v68, v69
    v_cvt_pk_bf16_f32 v125, v70, v71
    v_cvt_pk_bf16_f32 v126, v72, v73
    v_cvt_pk_bf16_f32 v127, v74, v75
    v_add_u32 v254, 55296, v240
    ds_read_b128 v[160:163], v254 offset:0
    ds_read_b128 v[164:167], v254 offset:3072
    ds_read_b128 v[168:171], v254 offset:6144
    s_waitcnt lgkmcnt(2)
    v_mfma_f32_32x32x16_bf16 v[128:143], v[160:163], v[80:83], 0
    ds_read_b128 v[172:175], v254 offset:9216
    s_waitcnt lgkmcnt(2)
    v_mfma_f32_32x32x16_bf16 v[128:143], v[164:167], v[84:87], v[128:143]
    ds_read_b128 v[64:67], v254 offset:12288
    s_waitcnt lgkmcnt(2)
    v_mfma_f32_32x32x16_bf16 v[128:143], v[168:171], v[88:91], v[128:143]
    ds_read_b128 v[68:71], v254 offset:15360
    s_waitcnt lgkmcnt(2)
    v_mfma_f32_32x32x16_bf16 v[128:143], v[172:175], v[92:95], v[128:143]
    ds_read_b128 v[72:75], v254 offset:1024
    s_waitcnt lgkmcnt(2)
    v_mfma_f32_32x32x16_bf16 v[128:143], v[64:67], v[96:99], v[128:143]
    ds_read_b128 v[76:79], v254 offset:4096
    s_waitcnt lgkmcnt(2)
    v_mfma_f32_32x32x16_bf16 v[128:143], v[68:71], v[100:103], v[128:143]
    ds_read_b128 v[160:163], v254 offset:7168
    s_waitcnt lgkmcnt(2)
    v_mfma_f32_32x32x16_bf16 v[144:159], v[72:75], v[80:83], 0
    ds_read_b128 v[164:167], v254 offset:10240
    s_waitcnt lgkmcnt(2)
    v_mfma_f32_32x32x16_bf16 v[144:159], v[76:79], v[84:87], v[144:159]
    ds_read_b128 v[168:171], v254 offset:13312
    s_waitcnt lgkmcnt(2)
    v_mfma_f32_32x32x16_bf16 v[144:159], v[160:163], v[88:91], v[144:159]
    ds_read_b128 v[172:175], v254 offset:16384
    s_setprio 3
    s_nop 0
    v_cvt_pk_bf16_f32 v128, v128, v129
    v_cvt_pk_bf16_f32 v129, v130, v131
    v_cvt_pk_bf16_f32 v130, v132, v133
    v_cvt_pk_bf16_f32 v131, v134, v135
    s_setprio 1
    s_waitcnt lgkmcnt(2)
    v_mfma_f32_32x32x16_bf16 v[144:159], v[164:167], v[92:95], v[144:159]
    ds_read_b128 v[64:67], v254 offset:2048
    ds_write_b128 v243, v[128:131] offset:0
    s_setprio 3
    v_cvt_pk_bf16_f32 v132, v136, v137
    v_cvt_pk_bf16_f32 v133, v138, v139
    v_cvt_pk_bf16_f32 v134, v140, v141
    v_cvt_pk_bf16_f32 v135, v142, v143
    s_setprio 1
    s_waitcnt lgkmcnt(3)
    v_mfma_f32_32x32x16_bf16 v[144:159], v[168:171], v[96:99], v[144:159]
    ds_read_b128 v[68:71], v254 offset:5120
    ds_write_b128 v243, v[132:135] offset:32
    s_waitcnt lgkmcnt(4)
    v_mfma_f32_32x32x16_bf16 v[144:159], v[172:175], v[100:103], v[144:159]
    ds_read_b128 v[72:75], v254 offset:8192
    s_waitcnt lgkmcnt(4)
    v_mfma_f32_32x32x16_bf16 v[48:63], v[64:67], v[80:83], 0
    ds_read_b128 v[76:79], v254 offset:11264
    s_waitcnt lgkmcnt(3)
    v_mfma_f32_32x32x16_bf16 v[48:63], v[68:71], v[84:87], v[48:63]
    ds_read_b128 v[160:163], v254 offset:14336
    s_waitcnt lgkmcnt(2)
    v_mfma_f32_32x32x16_bf16 v[48:63], v[72:75], v[88:91], v[48:63]
    ds_read_b128 v[164:167], v254 offset:17408
    s_setprio 3
    s_nop 0
    v_cvt_pk_bf16_f32 v144, v144, v145
    v_cvt_pk_bf16_f32 v145, v146, v147
    v_cvt_pk_bf16_f32 v146, v148, v149
    v_cvt_pk_bf16_f32 v147, v150, v151
    s_setprio 1
    s_waitcnt lgkmcnt(2)
    v_mfma_f32_32x32x16_bf16 v[48:63], v[76:79], v[92:95], v[48:63]
    ds_read_b128 v[168:171], v254 offset:0
    ds_write_b128 v243, v[144:147] offset:64
    s_setprio 3
    v_cvt_pk_bf16_f32 v148, v152, v153
    v_cvt_pk_bf16_f32 v149, v154, v155
    v_cvt_pk_bf16_f32 v150, v156, v157
    v_cvt_pk_bf16_f32 v151, v158, v159
    s_setprio 1
    s_waitcnt lgkmcnt(3)
    v_mfma_f32_32x32x16_bf16 v[48:63], v[160:163], v[96:99], v[48:63]
    ds_read_b128 v[172:175], v254 offset:3072
    ds_write_b128 v243, v[148:151] offset:96
    s_waitcnt lgkmcnt(4)
    v_mfma_f32_32x32x16_bf16 v[48:63], v[164:167], v[100:103], v[48:63]
    ds_read_b128 v[64:67], v254 offset:6144
    s_waitcnt lgkmcnt(4)
    v_mfma_f32_32x32x16_bf16 v[128:143], v[168:171], v[104:107], 0
    ds_read_b128 v[68:71], v254 offset:9216
    s_waitcnt lgkmcnt(3)
    v_mfma_f32_32x32x16_bf16 v[128:143], v[172:175], v[108:111], v[128:143]
    ds_read_b128 v[72:75], v254 offset:12288
    s_waitcnt lgkmcnt(2)
    v_mfma_f32_32x32x16_bf16 v[128:143], v[64:67], v[112:115], v[128:143]
    ds_read_b128 v[76:79], v254 offset:15360
    s_setprio 3
    s_nop 0
    v_cvt_pk_bf16_f32 v48, v48, v49
    v_cvt_pk_bf16_f32 v49, v50, v51
    v_cvt_pk_bf16_f32 v50, v52, v53
    v_cvt_pk_bf16_f32 v51, v54, v55
    s_setprio 1
    s_waitcnt lgkmcnt(2)
    v_mfma_f32_32x32x16_bf16 v[128:143], v[68:71], v[116:119], v[128:143]
    ds_read_b128 v[160:163], v254 offset:1024
    ds_write_b128 v245, v[48:51] offset:0
    s_setprio 3
    v_cvt_pk_bf16_f32 v52, v56, v57
    v_cvt_pk_bf16_f32 v53, v58, v59
    v_cvt_pk_bf16_f32 v54, v60, v61
    v_cvt_pk_bf16_f32 v55, v62, v63
    s_setprio 1
    s_waitcnt lgkmcnt(3)
    v_mfma_f32_32x32x16_bf16 v[128:143], v[72:75], v[120:123], v[128:143]
    ds_read_b128 v[164:167], v254 offset:4096
    ds_write_b128 v246, v[52:55] offset:0
    ds_read_b128 v[80:83], v244 offset:0
    ds_read_b128 v[84:87], v244 offset:1024
    s_waitcnt lgkmcnt(6)
    v_mfma_f32_32x32x16_bf16 v[128:143], v[76:79], v[124:127], v[128:143]
    ds_read_b128 v[168:171], v254 offset:7168
    ds_read_b128 v[88:91], v244 offset:2048
    ds_read_b128 v[92:95], v244 offset:3072
    ds_read_b128 v[96:99], v244 offset:4096
    s_waitcnt lgkmcnt(9)
    v_mfma_f32_32x32x16_bf16 v[144:159], v[160:163], v[104:107], 0
    ds_read_b128 v[172:175], v254 offset:10240
    ds_read_b128 v[100:103], v244 offset:5120
    s_setprio 3
    s_nop 2
    v_cvt_pk_bf16_f32 v128, v128, v129
    v_cvt_pk_bf16_f32 v129, v130, v131
    v_cvt_pk_bf16_f32 v130, v132, v133
    v_cvt_pk_bf16_f32 v131, v134, v135
    s_setprio 1
    s_waitcnt lgkmcnt(9)
    v_mfma_f32_32x32x16_bf16 v[144:159], v[164:167], v[108:111], v[144:159]
    ds_read_b128 v[64:67], v254 offset:13312
    s_waitcnt lgkmcnt(3)
    buffer_store_dwordx4 v[96:99], v248, s[20:23], s45 offen offset:0 sc0 sc1 nt
    ds_write_b128 v243, v[128:131] offset:0
    s_setprio 3
    v_cvt_pk_bf16_f32 v132, v136, v137
    v_cvt_pk_bf16_f32 v133, v138, v139
    v_cvt_pk_bf16_f32 v134, v140, v141
    v_cvt_pk_bf16_f32 v135, v142, v143
    s_setprio 1
    v_mfma_f32_32x32x16_bf16 v[144:159], v[168:171], v[112:115], v[144:159]
    ds_read_b128 v[68:71], v254 offset:16384
    s_waitcnt lgkmcnt(3)
    buffer_store_dwordx4 v[100:103], v249, s[20:23], s45 offen offset:0 sc0 sc1 nt
    ds_write_b128 v243, v[132:135] offset:32
    v_mfma_f32_32x32x16_bf16 v[144:159], v[172:175], v[116:119], v[144:159]
    ds_read_b128 v[72:75], v254 offset:2048
    buffer_store_dwordx4 v[80:83], v247, s[20:23], s44 offen offset:0 sc0 sc1 nt
    s_waitcnt lgkmcnt(4)
    v_mfma_f32_32x32x16_bf16 v[144:159], v[64:67], v[120:123], v[144:159]
    ds_read_b128 v[76:79], v254 offset:5120
    buffer_store_dwordx4 v[84:87], v248, s[20:23], s44 offen offset:0 sc0 sc1 nt
    s_waitcnt lgkmcnt(3)
    v_mfma_f32_32x32x16_bf16 v[144:159], v[68:71], v[124:127], v[144:159]
    ds_read_b128 v[160:163], v254 offset:8192
    buffer_store_dwordx4 v[88:91], v249, s[20:23], s44 offen offset:0 sc0 sc1 nt
    s_waitcnt lgkmcnt(2)
    v_mfma_f32_32x32x16_bf16 v[48:63], v[72:75], v[104:107], 0
    ds_read_b128 v[164:167], v254 offset:11264
    buffer_store_dwordx4 v[92:95], v247, s[20:23], s45 offen offset:0 sc0 sc1 nt
    s_setprio 3
    s_nop 4
    v_cvt_pk_bf16_f32 v144, v144, v145
    v_cvt_pk_bf16_f32 v145, v146, v147
    v_cvt_pk_bf16_f32 v146, v148, v149
    v_cvt_pk_bf16_f32 v147, v150, v151
    s_setprio 1
    s_waitcnt lgkmcnt(2)
    v_mfma_f32_32x32x16_bf16 v[48:63], v[76:79], v[108:111], v[48:63]
    ds_read_b128 v[168:171], v254 offset:14336
    ds_write_b128 v243, v[144:147] offset:64
    s_setprio 3
    v_cvt_pk_bf16_f32 v148, v152, v153
    v_cvt_pk_bf16_f32 v149, v154, v155
    v_cvt_pk_bf16_f32 v150, v156, v157
    v_cvt_pk_bf16_f32 v151, v158, v159
    s_setprio 1
    s_waitcnt lgkmcnt(3)
    v_mfma_f32_32x32x16_bf16 v[48:63], v[160:163], v[112:115], v[48:63]
    ds_read_b128 v[172:175], v254 offset:17408
    ds_write_b128 v243, v[148:151] offset:96
    s_waitcnt lgkmcnt(4)
    v_mfma_f32_32x32x16_bf16 v[48:63], v[164:167], v[116:119], v[48:63]
    s_waitcnt lgkmcnt(3)
    v_mfma_f32_32x32x16_bf16 v[48:63], v[168:171], v[120:123], v[48:63]
    s_waitcnt lgkmcnt(1)
    v_mfma_f32_32x32x16_bf16 v[48:63], v[172:175], v[124:127], v[48:63]
    s_setprio 3
    s_nop 10
    v_cvt_pk_bf16_f32 v48, v48, v49
    v_cvt_pk_bf16_f32 v49, v50, v51
    v_cvt_pk_bf16_f32 v50, v52, v53
    v_cvt_pk_bf16_f32 v51, v54, v55
    s_setprio 1
    ds_write_b128 v245, v[48:51] offset:0
    s_setprio 3
    v_cvt_pk_bf16_f32 v52, v56, v57
    v_cvt_pk_bf16_f32 v53, v58, v59
    v_cvt_pk_bf16_f32 v54, v60, v61
    v_cvt_pk_bf16_f32 v55, v62, v63
    s_setprio 1
    ds_write_b128 v246, v[52:55] offset:0
    ds_read_b128 v[128:131], v244 offset:0
    ds_read_b128 v[132:135], v244 offset:1024
    ds_read_b128 v[136:139], v244 offset:2048
    ds_read_b128 v[140:143], v244 offset:3072
    ds_read_b128 v[160:163], v244 offset:4096
    ds_read_b128 v[164:167], v244 offset:5120
    s_waitcnt lgkmcnt(5)
    buffer_store_dwordx4 v[128:131], v247, s[20:23], s46 offen offset:0 sc0 sc1 nt
    s_waitcnt lgkmcnt(4)
    buffer_store_dwordx4 v[132:135], v248, s[20:23], s46 offen offset:0 sc0 sc1 nt
    s_waitcnt lgkmcnt(3)
    buffer_store_dwordx4 v[136:139], v249, s[20:23], s46 offen offset:0 sc0 sc1 nt
    s_waitcnt lgkmcnt(2)
    buffer_store_dwordx4 v[140:143], v247, s[20:23], s47 offen offset:0 sc0 sc1 nt
    s_waitcnt lgkmcnt(1)
    buffer_store_dwordx4 v[160:163], v248, s[20:23], s47 offen offset:0 sc0 sc1 nt
    s_waitcnt lgkmcnt(0)
    buffer_store_dwordx4 v[164:167], v249, s[20:23], s47 offen offset:0 sc0 sc1 nt
    s_cmp_lg_u32 s63, 0
    s_cbranch_scc1 L_redo
    s_branch L_fin
L_ool4:
    s_mov_b32 exec_lo, 0x0
    s_mov_b32 exec_hi, 0xffff0000
    v_add_u32 v247, 0xfffffd00, v247
    s_not_b64 exec, exec
    v_add_u32 v247, 0x17d00, v247
    s_mov_b32 exec_lo, 0xffffffff
    s_mov_b32 exec_hi, 0x0
    v_add_u32 v248, 0xfffffd00, v248
    s_not_b64 exec, exec
    v_add_u32 v248, 0x17d00, v248
    s_mov_b32 exec_lo, 0xffff0000
    s_mov_b32 exec_hi, 0xffffffff
    v_add_u32 v249, 0xfffffd00, v249
    s_not_b64 exec, exec
    v_add_u32 v249, 0x17d00, v249
    s_mov_b64 exec, -1
    s_mov_b32 exec_lo, 0xf0f0f0f0
    s_mov_b32 exec_hi, 0x0f0f0f0f
    v_add_u32 v241, 11520, v241
    v_mov_b32 v242, v241
    s_mov_b64 exec, -1
    s_branch L_oolr4
.section .rodata,"a"
.p2align 6
.amdhsa_kernel standalone__window_attn_swin__vision_kernel
  .amdhsa_next_free_vgpr 256
  .amdhsa_next_free_sgpr 96
  .amdhsa_accum_offset 256
  .amdhsa_group_segment_fixed_size 0
  .amdhsa_kernarg_size 72
  .amdhsa_user_sgpr_count 2
  .amdhsa_user_sgpr_kernarg_segment_ptr 1
  .amdhsa_system_sgpr_workgroup_id_x 1
.end_amdhsa_kernel
```
